```python
import torch

def _softmax(x, axis=-1):
    return torch.softmax(x, dim=axis)
def _gelu(x):
    return torch.nn.functional.gelu(x, approximate="tanh")
def _silu(x):
    return torch.nn.functional.silu(x)
def _sigmoid(x):
    return torch.sigmoid(x)
def _layernorm(x, axis=-1, eps=1e-5):
    m = x.mean(dim=axis, keepdim=True)
    v = x.var(dim=axis, keepdim=True, unbiased=False)
    return (x - m) / torch.sqrt(v + eps)
def _scatter_add(tgt, idx, src, axis=0):
    return tgt.clone().index_add_(axis, idx, src)
def _segment_sum(src, seg, n):
    out = torch.zeros((n,) + src.shape[1:], dtype=src.dtype)
    return out.index_add_(0, seg, src)
def _pad(x, pw):
    flat = tuple(v for pair in reversed(pw) for v in pair)
    return torch.nn.functional.pad(x, flat)

kernel_name = 'standalone__mpnn_edge_mlp__graph'

def setup_inputs():

    _w = (lambda a: (lambda t: t.to(torch.bfloat16) if t.is_floating_point() else t)(torch.as_tensor(a)))
    N, deg, D, De = 10000, 16, 128, max(16, 1)
    E = N * deg
    return {
        "x": _w((lambda *s: torch.randn(*s, dtype=torch.bfloat16) * 0.05)(N, D)),
        "e_attr": _w((lambda *s: torch.randn(*s, dtype=torch.bfloat16) * 0.4)(E, De)),
        "src": _w((lambda lo, hi, *s: torch.randint(lo, hi, s))(0, N, E).to(torch.int64)),
        "dst": _w((lambda lo, hi, *s: torch.randint(lo, hi, s))(0, N, E).to(torch.int64)),
        "w_msg": _w((lambda *s: torch.randn(*s, dtype=torch.bfloat16) * 0.4)(2 * D + De, D)),
        "w_upd": _w((lambda *s: torch.randn(*s, dtype=torch.bfloat16) * 0.05)(2 * D, D)),
    }

def reference(x, e_attr, src, dst, w_msg, w_upd):
    N, D = x.shape
    m_in = torch.concatenate([x[src], x[dst], e_attr], axis=-1)
    msg = _silu(m_in @ w_msg)
    agg = _segment_sum(msg, dst, N)
    return _silu(torch.concatenate([x, agg], axis=-1) @ w_upd)
```

```asm
; @launch grid=(250,1,1) block=(512,1,1) lds=163840
.amdgcn_target "amdgcn-amd-amdhsa--gfx950"
.text
.globl standalone__mpnn_edge_mlp__graph_kernel
.p2align 8
.type standalone__mpnn_edge_mlp__graph_kernel,@function
standalone__mpnn_edge_mlp__graph_kernel:
    s_load_dwordx2 s[4:5], s[0:1], 0
    s_load_dwordx2 s[32:33], s[0:1], 64
    s_load_dwordx2 s[20:21], s[0:1], 32
    s_load_dwordx2 s[16:17], s[0:1], 24
    s_load_dwordx2 s[12:13], s[0:1], 16
    s_load_dwordx2 s[24:25], s[0:1], 40
    s_load_dwordx2 s[8:9], s[0:1], 8
    s_cmp_ge_u32 s2, 250
    s_cbranch_scc1 L_end
    v_lshrrev_b32 v52, 6, v0
    v_and_b32 v1, 63, v0
    v_readfirstlane_b32 s40, v52
    v_lshlrev_b32 v2, 4, v0
    s_sub_u32 s49, s2, 157
    s_sub_u32 s50, s2, 0
    s_cmp_lt_u32 s49, 64
    s_cbranch_scc1 L_sort
L_ent2:
    v_lshrrev_b32 v53, 4, v1
    v_and_b32 v55, 15, v1
    v_lshrrev_b32 v54, 3, v0
    v_and_or_b32 v54, v54, 8, v53
    v_xor_b32 v54, v54, v55
    v_lshlrev_b32 v54, 4, v54
    v_lshl_add_u32 v33, v53, 8, v54
    v_xor_b32 v34, 64, v33
    v_lshlrev_b32 v54, 2, v53
    v_xor_b32 v54, v54, v55
    v_lshlrev_b32 v54, 4, v54
    v_lshl_add_u32 v3, v53, 8, v54
    s_lshl_b32 s45, s40, 12
    s_lshl_b32 s46, s40, 11
    s_mov_b32 s6, 0x271000
    s_mov_b32 s7, 0x20000
    s_mov_b32 s22, 0x11000
    s_mov_b32 s23, 0x20000
    s_cmp_ge_u32 s50, 157
    s_cbranch_scc1 L_notpm
    s_add_u32 m0, s46, 80128
    s_lshl_b32 s75, s50, 14
    s_add_u32 s47, s75, s46
    s_waitcnt lgkmcnt(0)
    buffer_load_dwordx4 v33, s[4:7], s47 offen nt lds
    buffer_load_dwordx4 v34, s[4:7], s47 offen offset:1024 nt lds
    s_mov_b32 m0, s45
    s_nop 0
    buffer_load_dwordx4 v3, s[20:23], s45 offen offset:0 lds
    buffer_load_dwordx4 v3, s[20:23], s45 offen offset:1024 lds
    buffer_load_dwordx4 v3, s[20:23], s45 offen offset:2048 lds
    buffer_load_dwordx4 v3, s[20:23], s45 offen offset:3072 lds
    s_mov_b32 s18, 0x9c400
    s_mov_b32 s19, 0x20000
    s_mov_b32 s14, 0x9c400
    s_mov_b32 s15, 0x20000
    s_mov_b32 s34, 0x500000
    s_mov_b32 s35, 0x20000
    s_mov_b32 s26, 0x10000
    s_mov_b32 s27, 0x20000
    s_mov_b32 s30, 0x271000
    s_mov_b32 s31, 0x20000
    s_mov_b32 s10, 0x27100
    s_mov_b32 s11, 0x20000
    s_mov_b32 s38, 0x2710
    s_mov_b32 s39, 0x20000
    s_and_b32 s41, s40, 3
    s_lshr_b32 s42, s40, 2
    s_mov_b32 s62, 0x80808080
    s_mov_b32 s63, 0x80808080
    s_mov_b32 s52, 0xbfb8aa3b
    s_mov_b32 s53, 0xbfb8aa3b
    s_lshl_b32 s48, s2, 2
    s_add_u32 s77, s48, 0x210000
    s_add_u32 s48, s48, 0x200000
    s_mov_b32 s68, 0
    s_waitcnt lgkmcnt(0)
    s_add_u32 s32, s32, 0x0
    s_addc_u32 s33, s33, 0
    s_load_dword s43, s[32:33], s48
    s_load_dwordx2 s[28:29], s[0:1], 48
    s_cmp_lg_u32 s40, 7
    s_cbranch_scc1 L_setup
    s_mov_b32 s68, 1
    s_mov_b32 s47, 0x200000
    v_lshlrev_b32 v52, 4, v1
    buffer_load_dwordx4 v[212:215], v52, s[32:35], s47 offen
L_setup:
    v_mov_b32 v56, 0
    v_mov_b32 v60, 0x100000
    v_mov_b32 v57, 0
    v_mov_b32 v61, 0x100000
    v_mov_b32 v58, 0
    v_mov_b32 v62, 0x100000
    v_mov_b32 v59, 0
    v_mov_b32 v63, 0x100000
    v_add_u32 v64, 112960, v2
    ds_write_b128 v64, v[56:59] offset:0
    ds_write_b128 v64, v[56:59] offset:8192
    ds_write_b128 v64, v[56:59] offset:16384
    ds_write_b128 v64, v[56:59] offset:24576
    ds_write_b128 v64, v[56:59] offset:32768
    ds_write_b128 v64, v[60:63] offset:41280
    s_cmp_lg_u32 s40, 0
    s_cbranch_scc1 L_il_1
    ds_write_b128 v64, v[60:63] offset:49472
    s_mov_b64 exec, 0xfffff
    ds_write_b128 v64, v[56:59] offset:40960
    s_mov_b64 exec, 0xf
    v_cmp_eq_u32 vcc, 2, v0
    v_mov_b32 v61, 1152
    v_add_u32 v60, 112896, v2
    v_cndmask_b32 v56, 0, v61, vcc
    ds_write_b128 v60, v[56:59]
    s_mov_b64 exec, -1
L_il_1:
    v_lshlrev_b32 v60, 2, v1
    v_mov_b32 v61, 0
    v_add_u32 v60, 79872, v60
    ds_write_b32 v60, v61
    v_lshrrev_b32 v52, 4, v1
    v_bfe_u32 v53, v1, 2, 2
    v_and_b32 v54, 3, v1
    v_lshrrev_b32 v55, 5, v1
    v_and_b32 v56, 31, v1
    v_xor_b32 v57, s41, v53
    v_lshlrev_b32 v57, 6, v57
    v_lshl_add_u32 v57, v53, 8, v57
    v_and_b32 v58, 1, v52
    v_lshl_add_u32 v35, v55, 11, v57
    v_lshl_add_u32 v35, v58, 5, v35
    v_lshl_add_u32 v35, v54, 3, v35
    v_add_u32 v35, 32768, v35
    v_and_b32 v59, 1, v54
    v_lshl_add_u32 v57, v59, 5, v57
    v_lshl_add_u32 v57, v58, 4, v57
    v_lshrrev_b32 v59, 1, v54
    v_lshl_add_u32 v57, v59, 3, v57
    v_lshl_add_u32 v36, v55, 11, v57
    v_lshl_add_u32 v37, v55, 10, v57
    v_add_u32 v37, 49152, v37
    s_or_b32 s9, s9, 0x200000
    s_add_u32 s36, s32, 0x280000
    s_addc_u32 s37, s33, 0
    s_or_b32 s37, s37, 0x1000000
    s_mov_b32 s54, 0xbf317218
    s_mov_b32 s55, 0xbf317218
    s_lshl_b32 s76, s2, 13
    s_mov_b32 s71, 0
    s_mov_b32 s69, 0
    v_mov_b32 v27, 2
    v_mov_b32 v28, 0x3f80
    v_mov_b32 v30, 112896
    v_mov_b32 v31, 102016
    v_mov_b32 v32, 154240
    s_mul_i32 s47, s42, 20
    v_add_u32 v57, s47, v56
    v_cmp_gt_u32 vcc, 20, v56
    v_mov_b32 v58, 40
    v_lshlrev_b32 v48, 8, v56
    v_cndmask_b32 v58, v58, v57, vcc
    v_lshl_add_u32 v48, v55, 5, v48
    v_mov_b32 v59, 0x400000
    v_cndmask_b32 v48, v59, v48, vcc
    s_mul_i32 s78, s2, 10240
    s_mul_i32 s48, s42, 5120
    s_add_u32 s78, s78, s48
    s_lshl_b32 s48, s41, 6
    s_add_u32 s78, s78, s48
    s_mul_i32 s48, s42, 19392
    v_and_b32 v59, 15, v58
    v_xor_b32 v59, v59, v55
    v_lshlrev_b32 v59, 4, v59
    v_lshl_add_u32 v38, v58, 8, v59
    v_add_u32 v38, 69632, v38
    s_add_u32 s48, s48, 112960
    v_min_u32 v57, 23, v56
    v_mul_u32_u24 v13, 912, v57
    v_lshl_add_u32 v13, v55, 4, v13
    v_add_u32 v13, s48, v13
    v_lshl_add_u32 v57, v55, 2, v53
    v_mul_u32_u24 v14, 912, v57
    v_and_b32 v58, 1, v52
    v_lshl_add_u32 v14, v58, 5, v14
    v_and_b32 v59, 1, v54
    v_lshl_add_u32 v14, v59, 4, v14
    v_lshrrev_b32 v59, 1, v54
    v_lshl_add_u32 v14, v59, 3, v14
    v_add_u32 v14, s48, v14
    s_mul_i32 s72, s40, 6144
    s_mul_i32 s74, s40, 3072
    s_add_u32 s74, s74, 88320
    v_lshl_add_u32 v39, v1, 5, v30
    v_lshl_add_u32 v46, v1, 4, s72
    s_mul_i32 s48, s42, 24576
    v_lshl_add_u32 v47, v1, 4, s48
    v_lshlrev_b32 v57, 8, v55
    v_lshl_add_u32 v11, v56, 1, v57
    v_add_u32 v11, s72, v11
    v_mov_b32 v57, v54
    s_lshl_b32 s47, s41, 6
    v_lshl_add_u32 v19, v57, 4, s47
    v_mov_b32 v21, v19
    v_bfe_u32 v59, v1, 3, 1
    v_xor_b32 v57, v59, v55
    v_lshlrev_b32 v57, 4, v57
    v_lshl_add_u32 v12, v56, 5, v57
    v_add_u32 v12, s74, v12
    s_mul_i32 s47, s42, 4608
    s_add_u32 s47, s47, 154240
    v_lshlrev_b32 v57, 3, v53
    v_lshl_add_u32 v57, v55, 5, v57
    v_lshl_add_u32 v57, v58, 6, v57
    v_add_u32 v15, s47, v57
    v_bfe_u32 v57, v1, 1, 2
    v_lshlrev_b32 v57, 3, v57
    v_lshl_add_u32 v57, v58, 5, v57
    v_lshl_add_u32 v57, v59, 6, v57
    v_lshl_add_u32 v57, v55, 7, v57
    v_add_u32 v16, s47, v57
    v_xor_b32 v57, v1, v58
    v_and_b32 v57, 1, v57
    v_lshlrev_b32 v23, 4, v57
    v_lshrrev_b32 v57, 3, v0
    v_mul_u32_u24 v17, 2500, v57
    s_mul_i32 s47, s42, 78
    v_add_lshl_u32 v43, v1, s47, 10
    v_add_u32 v45, 0x10000, v43
    v_cndmask_b32 v40, 0, -1, s[62:63]
    s_cmp_ge_u32 s50, 157
    s_cbranch_scc1 L_notpm2
    s_lshl_b32 s47, s42, 5
    v_add_u32 v57, s47, v56
    v_and_b32 v59, 15, v56
    v_xor_b32 v58, v59, v55
    v_lshlrev_b32 v57, 8, v57
    v_add_u32 v57, 80128, v57
    v_lshl_add_u32 v184, v58, 4, v57
    s_lshl_b32 s47, s41, 2
    v_lshl_add_u32 v58, v55, 1, s47
    v_xor_b32 v58, v58, v59
    v_lshl_add_u32 v185, v58, 4, v57
    v_xor_b32 v186, 16, v185
    v_lshlrev_b32 v187, 4, v1
    v_add_u32 v188, 96512, v187
    v_xor_b32 v189, 128, v33
    v_xor_b32 v190, 128, v34
    s_add_u32 s75, s75, 0x280000
    s_cmp_ge_u32 s40, 5
    s_cbranch_scc1 L_g_2
    s_add_u32 m0, s46, 69632
    s_mul_i32 s47, s2, 10240
    s_add_u32 s47, s47, s46
    buffer_load_dwordx4 v33, s[4:7], s47 offen lds
    buffer_load_dwordx4 v34, s[4:7], s47 offen offset:1024 lds
    s_branch L_g_3
L_g_2:
    s_and_b32 s47, s46, 2048
    s_add_u32 s47, s47, 65536
    s_mov_b32 m0, s47
    s_nop 0
    buffer_load_dwordx4 v3, s[20:23], s47 offen offset:0 lds
    buffer_load_dwordx4 v3, s[20:23], s47 offen offset:1024 lds
L_g_3:
    s_add_u32 s47, s45, 32768
    s_mov_b32 m0, s47
    s_nop 0
    buffer_load_dwordx4 v3, s[20:23], s47 offen offset:0 lds
    buffer_load_dwordx4 v3, s[20:23], s47 offen offset:1024 lds
    buffer_load_dwordx4 v3, s[20:23], s47 offen offset:2048 lds
    buffer_load_dwordx4 v3, s[20:23], s47 offen offset:3072 lds
    s_waitcnt vmcnt(6) lgkmcnt(0)
    s_barrier
    ds_read_b64_tr_b16 v[112:113], v36 offset:0
    ds_read_b64_tr_b16 v[114:115], v36 offset:1024
    ds_read_b128 v[144:147], v184
    ds_read_b64_tr_b16 v[116:117], v36 offset:4096
    ds_read_b64_tr_b16 v[118:119], v36 offset:5120
    v_xor_b32 v57, 32, v184
    ds_read_b128 v[148:151], v57
    ds_read_b64_tr_b16 v[120:121], v36 offset:8192
    ds_read_b64_tr_b16 v[122:123], v36 offset:9216
    v_xor_b32 v57, 64, v184
    ds_read_b128 v[152:155], v57
    ds_read_b64_tr_b16 v[124:125], v36 offset:12288
    ds_read_b64_tr_b16 v[126:127], v36 offset:13312
    v_xor_b32 v57, 96, v184
    ds_read_b128 v[156:159], v57
    ds_read_b64_tr_b16 v[128:129], v36 offset:16384
    ds_read_b64_tr_b16 v[130:131], v36 offset:17408
    v_xor_b32 v57, 128, v184
    ds_read_b128 v[160:163], v57
    s_waitcnt lgkmcnt(12)
    v_mfma_f32_32x32x16_bf16 v[80:95], v[112:115], v[144:147], 0
    ds_read_b64_tr_b16 v[132:133], v36 offset:20480
    ds_read_b64_tr_b16 v[134:135], v36 offset:21504
    v_xor_b32 v57, 160, v184
    ds_read_b128 v[164:167], v57
    s_waitcnt lgkmcnt(12)
    v_mfma_f32_32x32x16_bf16 v[80:95], v[116:119], v[148:151], v[80:95]
    ds_read_b64_tr_b16 v[136:137], v36 offset:24576
    ds_read_b64_tr_b16 v[138:139], v36 offset:25600
    v_xor_b32 v57, 192, v184
    ds_read_b128 v[168:171], v57
    s_waitcnt lgkmcnt(12)
    v_mfma_f32_32x32x16_bf16 v[80:95], v[120:123], v[152:155], v[80:95]
    ds_read_b64_tr_b16 v[140:141], v36 offset:28672
    ds_read_b64_tr_b16 v[142:143], v36 offset:29696
    v_xor_b32 v57, 224, v184
    ds_read_b128 v[172:175], v57
    s_waitcnt lgkmcnt(12)
    v_mfma_f32_32x32x16_bf16 v[80:95], v[124:127], v[156:159], v[80:95]
    s_waitcnt lgkmcnt(9)
    v_mfma_f32_32x32x16_bf16 v[80:95], v[128:131], v[160:163], v[80:95]
    s_waitcnt lgkmcnt(6)
    v_mfma_f32_32x32x16_bf16 v[80:95], v[132:135], v[164:167], v[80:95]
    s_waitcnt lgkmcnt(3)
    v_mfma_f32_32x32x16_bf16 v[80:95], v[136:139], v[168:171], v[80:95]
    s_waitcnt lgkmcnt(0)
    v_mfma_f32_32x32x16_bf16 v[80:95], v[140:143], v[172:175], v[80:95]
    s_nop 7
    s_nop 3
    v_pk_mul_f32 v[80:81], v[80:81], s[52:53]
    v_pk_mul_f32 v[82:83], v[82:83], s[52:53]
    v_pk_mul_f32 v[84:85], v[84:85], s[52:53]
    v_pk_mul_f32 v[86:87], v[86:87], s[52:53]
    v_pk_mul_f32 v[88:89], v[88:89], s[52:53]
    v_pk_mul_f32 v[90:91], v[90:91], s[52:53]
    v_pk_mul_f32 v[92:93], v[92:93], s[52:53]
    v_pk_mul_f32 v[94:95], v[94:95], s[52:53]
    v_cvt_pk_bf16_f32 v216, v80, v81
    v_cvt_pk_bf16_f32 v217, v82, v83
    v_cvt_pk_bf16_f32 v218, v84, v85
    v_cvt_pk_bf16_f32 v219, v86, v87
    v_cvt_pk_bf16_f32 v220, v88, v89
    v_cvt_pk_bf16_f32 v221, v90, v91
    v_cvt_pk_bf16_f32 v222, v92, v93
    v_cvt_pk_bf16_f32 v223, v94, v95
    ds_write_b128 v185, v[216:219] offset:16384
    ds_write_b128 v186, v[220:223] offset:16384
    s_cmp_eq_u32 s40, 7
    s_waitcnt lgkmcnt(0)
    s_barrier
    s_cbranch_scc0 L_pmdma
    ds_read_b128 v[112:115], v188 offset:0
    ds_read_b128 v[116:119], v188 offset:1024
    ds_read_b128 v[120:123], v188 offset:2048
    ds_read_b128 v[124:127], v188 offset:3072
    ds_read_b128 v[128:131], v188 offset:4096
    ds_read_b128 v[132:135], v188 offset:5120
    ds_read_b128 v[136:139], v188 offset:6144
    ds_read_b128 v[140:143], v188 offset:7168
    ds_read_b128 v[144:147], v188 offset:8192
    s_waitcnt lgkmcnt(8)
    buffer_store_dwordx4 v[112:115], v189, s[32:35], s75 offen offset:0 sc1
    ds_read_b128 v[148:151], v188 offset:9216
    s_waitcnt lgkmcnt(8)
    buffer_store_dwordx4 v[116:119], v190, s[32:35], s75 offen offset:1024 sc1
    ds_read_b128 v[152:155], v188 offset:10240
    s_waitcnt lgkmcnt(8)
    buffer_store_dwordx4 v[120:123], v33, s[32:35], s75 offen offset:2048 sc1
    ds_read_b128 v[156:159], v188 offset:11264
    s_waitcnt lgkmcnt(8)
    buffer_store_dwordx4 v[124:127], v34, s[32:35], s75 offen offset:3072 sc1
    s_add_u32 s75, s75, 4096
    ds_read_b128 v[160:163], v188 offset:12288
    s_waitcnt lgkmcnt(8)
    buffer_store_dwordx4 v[128:131], v189, s[32:35], s75 offen offset:0 sc1
    ds_read_b128 v[164:167], v188 offset:13312
    s_waitcnt lgkmcnt(8)
    buffer_store_dwordx4 v[132:135], v190, s[32:35], s75 offen offset:1024 sc1
    ds_read_b128 v[168:171], v188 offset:14336
    s_waitcnt lgkmcnt(8)
    buffer_store_dwordx4 v[136:139], v33, s[32:35], s75 offen offset:2048 sc1
    ds_read_b128 v[172:175], v188 offset:15360
    s_waitcnt lgkmcnt(8)
    buffer_store_dwordx4 v[140:143], v34, s[32:35], s75 offen offset:3072 sc1
    s_add_u32 s75, s75, 4096
    s_waitcnt lgkmcnt(7)
    buffer_store_dwordx4 v[144:147], v189, s[32:35], s75 offen offset:0 sc1
    s_waitcnt lgkmcnt(6)
    buffer_store_dwordx4 v[148:151], v190, s[32:35], s75 offen offset:1024 sc1
    s_waitcnt lgkmcnt(5)
    buffer_store_dwordx4 v[152:155], v33, s[32:35], s75 offen offset:2048 sc1
    s_waitcnt lgkmcnt(4)
    buffer_store_dwordx4 v[156:159], v34, s[32:35], s75 offen offset:3072 sc1
    s_add_u32 s75, s75, 4096
    s_waitcnt lgkmcnt(3)
    buffer_store_dwordx4 v[160:163], v189, s[32:35], s75 offen offset:0 sc1
    s_waitcnt lgkmcnt(2)
    buffer_store_dwordx4 v[164:167], v190, s[32:35], s75 offen offset:1024 sc1
    s_waitcnt lgkmcnt(1)
    buffer_store_dwordx4 v[168:171], v33, s[32:35], s75 offen offset:2048 sc1
    s_waitcnt lgkmcnt(0)
    buffer_store_dwordx4 v[172:175], v34, s[32:35], s75 offen offset:3072 sc1
    s_waitcnt vmcnt(16)
    s_mov_b32 s48, 0x9e3779b1
    v_mul_lo_u32 v212, v212, s48
    v_xor_b32 v212, 0x5bd1e995, v212
    v_mul_lo_u32 v213, v213, s48
    v_xor_b32 v213, 0x5bd1e995, v213
    v_mul_lo_u32 v214, v214, s48
    v_xor_b32 v214, 0x5bd1e995, v214
    v_mul_lo_u32 v215, v215, s48
    v_xor_b32 v215, 0x5bd1e995, v215
    s_branch L_q0
L_pmdma:
    s_waitcnt vmcnt(0)
    s_barrier
    s_mov_b32 m0, s45
    s_nop 0
    buffer_load_dwordx4 v3, s[24:27], s45 offen offset:0 lds
    buffer_load_dwordx4 v3, s[24:27], s45 offen offset:1024 lds
    buffer_load_dwordx4 v3, s[24:27], s45 offen offset:2048 lds
    buffer_load_dwordx4 v3, s[24:27], s45 offen offset:3072 lds
    s_mov_b32 s47, 28672
    s_mov_b32 m0, s47
    s_cmp_lg_u32 s40, 6
    s_cbranch_scc1 L_q
    buffer_load_dwordx4 v3, s[24:27], s47 offen offset:0 lds
    buffer_load_dwordx4 v3, s[24:27], s47 offen offset:1024 lds
    buffer_load_dwordx4 v3, s[24:27], s47 offen offset:2048 lds
    buffer_load_dwordx4 v3, s[24:27], s47 offen offset:3072 lds
    s_branch L_q
L_q0:
    s_barrier
L_q:
    ds_read_b64_tr_b16 v[112:113], v35 offset:0
    ds_read_b64_tr_b16 v[114:115], v35 offset:1024
    ds_read_b128 v[144:147], v38
    ds_read_b64_tr_b16 v[116:117], v35 offset:4096
    ds_read_b64_tr_b16 v[118:119], v35 offset:5120
    v_xor_b32 v58, 32, v38
    ds_read_b128 v[148:151], v58
    ds_read_b64_tr_b16 v[120:121], v35 offset:8192
    ds_read_b64_tr_b16 v[122:123], v35 offset:9216
    v_xor_b32 v58, 64, v38
    ds_read_b128 v[152:155], v58
    ds_read_b64_tr_b16 v[124:125], v35 offset:12288
    ds_read_b64_tr_b16 v[126:127], v35 offset:13312
    v_xor_b32 v58, 96, v38
    ds_read_b128 v[156:159], v58
    ds_read_b64_tr_b16 v[128:129], v35 offset:16384
    ds_read_b64_tr_b16 v[130:131], v35 offset:17408
    v_xor_b32 v58, 128, v38
    ds_read_b128 v[160:163], v58
    s_waitcnt lgkmcnt(12)
    v_mfma_f32_32x32x16_bf16 v[80:95], v[144:147], v[112:115], 0
    ds_read_b64_tr_b16 v[132:133], v35 offset:20480
    ds_read_b64_tr_b16 v[134:135], v35 offset:21504
    v_xor_b32 v58, 160, v38
    ds_read_b128 v[164:167], v58
    s_waitcnt lgkmcnt(12)
    v_mfma_f32_32x32x16_bf16 v[80:95], v[148:151], v[116:119], v[80:95]
    ds_read_b64_tr_b16 v[136:137], v35 offset:24576
    ds_read_b64_tr_b16 v[138:139], v35 offset:25600
    v_xor_b32 v58, 192, v38
    ds_read_b128 v[168:171], v58
    s_waitcnt lgkmcnt(12)
    v_mfma_f32_32x32x16_bf16 v[80:95], v[152:155], v[120:123], v[80:95]
    ds_read_b64_tr_b16 v[140:141], v35 offset:28672
    ds_read_b64_tr_b16 v[142:143], v35 offset:29696
    v_xor_b32 v58, 224, v38
    ds_read_b128 v[172:175], v58
    s_waitcnt lgkmcnt(12)
    v_mfma_f32_32x32x16_bf16 v[80:95], v[156:159], v[124:127], v[80:95]
    ds_read_b64_tr_b16 v[68:69], v35 offset:32768
    ds_read_b64_tr_b16 v[70:71], v35 offset:33792
    s_waitcnt lgkmcnt(11)
    v_mfma_f32_32x32x16_bf16 v[80:95], v[160:163], v[128:131], v[80:95]
    s_waitcnt lgkmcnt(8)
    v_mfma_f32_32x32x16_bf16 v[80:95], v[164:167], v[132:135], v[80:95]
    s_waitcnt lgkmcnt(5)
    v_mfma_f32_32x32x16_bf16 v[80:95], v[168:171], v[136:139], v[80:95]
    s_waitcnt lgkmcnt(2)
    v_mfma_f32_32x32x16_bf16 v[80:95], v[172:175], v[140:143], v[80:95]
    s_mul_i32 s44, s43, 0x9e3779b1
    s_xor_b32 s44, s44, 0x5bd1e995
    s_add_u32 s47, s44, 1
    v_and_b32 v41, s47, v40
    v_mov_b32 v42, s44
    v_mov_b32 v44, s44
    s_add_u32 m0, s45, 49152
    s_add_u32 s47, s45, 32768
    s_waitcnt lgkmcnt(0)
    s_barrier
    buffer_load_dwordx4 v[52:55], v2, s[32:35], s76 offen sc1
    v_lshlrev_b32 v60, 16, v68
    v_and_b32 v61, 0xffff0000, v68
    v_mul_f32 v60, s52, v60
    v_mul_f32 v61, s52, v61
    v_cvt_pk_bf16_f32 v68, v60, v61
    v_lshlrev_b32 v62, 16, v69
    v_and_b32 v63, 0xffff0000, v69
    v_mul_f32 v62, s52, v62
    v_mul_f32 v63, s52, v63
    v_cvt_pk_bf16_f32 v69, v62, v63
    v_lshlrev_b32 v64, 16, v70
    v_and_b32 v65, 0xffff0000, v70
    v_mul_f32 v64, s52, v64
    v_mul_f32 v65, s52, v65
    v_cvt_pk_bf16_f32 v70, v64, v65
    v_lshlrev_b32 v66, 16, v71
    v_and_b32 v67, 0xffff0000, v71
    v_mul_f32 v66, s52, v66
    v_mul_f32 v67, s52, v67
    v_cvt_pk_bf16_f32 v71, v66, v67
    v_pk_mul_f32 v[80:81], v[80:81], s[52:53]
    v_pk_mul_f32 v[82:83], v[82:83], s[52:53]
    v_pk_mul_f32 v[84:85], v[84:85], s[52:53]
    v_pk_mul_f32 v[86:87], v[86:87], s[52:53]
    v_pk_mul_f32 v[88:89], v[88:89], s[52:53]
    v_pk_mul_f32 v[90:91], v[90:91], s[52:53]
    v_pk_mul_f32 v[92:93], v[92:93], s[52:53]
    v_pk_mul_f32 v[94:95], v[94:95], s[52:53]
    v_cvt_pk_bf16_f32 v72, v80, v81
    v_cvt_pk_bf16_f32 v73, v82, v83
    v_cvt_pk_bf16_f32 v74, v84, v85
    v_cvt_pk_bf16_f32 v75, v86, v87
    v_cvt_pk_bf16_f32 v76, v88, v89
    v_cvt_pk_bf16_f32 v77, v90, v91
    v_cvt_pk_bf16_f32 v78, v92, v93
    v_cvt_pk_bf16_f32 v79, v94, v95
    s_cmp_eq_u32 s68, 0
    s_cbranch_scc1 L_nf_4
    s_lshl_b32 s48, s50, 10
    s_add_u32 s48, s48, 0x210000
    v_lshlrev_b32 v57, 4, v1
    s_waitcnt vmcnt(1)
    buffer_store_dwordx4 v[212:215], v57, s[32:35], s48 offen sc1
L_nf_4:
    buffer_load_dwordx4 v3, s[24:27], s47 offen offset:0 lds
    buffer_load_dwordx4 v3, s[24:27], s47 offen offset:1024 lds
    buffer_load_dwordx4 v3, s[24:27], s47 offen offset:2048 lds
    buffer_load_dwordx4 v3, s[24:27], s47 offen offset:3072 lds
    s_mov_b32 s48, 912
    s_cmp_lg_u32 s68, 0
    s_waitcnt vmcnt(5)
    s_cbranch_scc1 L_poll
    s_waitcnt vmcnt(4)
L_poll:
    v_xor_b32 v58, v55, v40
    v_add3_u32 v59, v52, v53, v54
    v_add3_u32 v58, v58, v59, v41
    v_and_b32 v185, 63, v52
    v_cmp_ne_u32 s[56:57], 0, v52
    v_add_u32_dpp v58, v58, v58 quad_perm:[1,0,3,2] row_mask:0xf bank_mask:0xf
    v_cmp_le_u32 s[60:61], 32, v185
    v_cmp_ne_u32 s[58:59], 0, v53
    v_add_u32_dpp v58, v58, v58 quad_perm:[2,3,0,1] row_mask:0xf bank_mask:0xf
    s_andn2_b64 s[64:65], s[56:57], s[60:61]
    s_bcnt1_i32_b64 s70, s[64:65]
    v_add_u32_dpp v58, v58, v58 row_half_mirror row_mask:0xf bank_mask:0xf
    s_bcnt1_i32_b64 s73, s[60:61]
    v_cmp_ne_u32 vcc, 0, v58
    s_cbranch_vccnz L_notyet
L_got:
    s_lshl_b32 s70, s70, 1
    s_lshl_b32 s73, s73, 1
    v_mov_b32 v192, s70
    v_writelane_b32 v192, s73, 1
    s_mov_b64 exec, 3
    ds_add_rtn_u32 v192, v39, v192
    s_mov_b64 exec, s[58:59]
    v_and_or_b32 v188, v53, 32, v30
    ds_add_rtn_u32 v188, v188, v27
    s_mov_b64 exec, -1
    v_mbcnt_lo_u32_b32 v193, s64, 0
    v_mbcnt_lo_u32_b32 v194, s60, 0
    v_mbcnt_hi_u32_b32 v193, s65, v193
    v_mbcnt_hi_u32_b32 v194, s61, v194
    v_bfe_u32 v187, v52, 6, 12
    v_mad_u32_u24 v185, v185, s48, v31
    v_lshrrev_b32 v186, 18, v52
    v_add_u32 v187, v187, v17
    v_and_b32 v189, 63, v53
    v_bfe_u32 v191, v53, 6, 12
    v_mad_u32_u24 v189, v189, s48, v31
    v_lshrrev_b32 v190, 18, v53
    v_add_u32 v191, v191, v17
    v_cmp_ne_u32 vcc, 0, v54
    s_waitcnt lgkmcnt(0)
    v_readlane_b32 s70, v192, 0
    v_readlane_b32 s73, v192, 1
    s_mov_b64 exec, s[58:59]
    v_add_u32 v189, v189, v188
    v_lshl_add_u32 v188, v188, 2, v32
    ds_write_b16 v189, v28
    ds_write_b64 v188, v[190:191]
    s_mov_b64 exec, s[56:57]
    v_lshl_add_u32 v193, v193, 1, s70
    v_lshl_add_u32 v194, v194, 1, s73
    v_cndmask_b32 v184, v193, v194, s[60:61]
    v_add_u32 v185, v185, v184
    v_lshl_add_u32 v184, v184, 2, v32
    ds_write_b16 v185, v28
    ds_write_b64 v184, v[186:187]
    s_mov_b64 exec, -1
    s_cbranch_vccz L_placed
    v_cndmask_b32 v55, v55, 0, s[62:63]
    v_cmp_ne_u32 s[56:57], 0, v54
    v_cmp_ne_u32 s[58:59], 0, v55
    s_mov_b64 exec, s[56:57]
    v_and_or_b32 v184, v54, 32, v30
    ds_add_rtn_u32 v184, v184, v27
    s_mov_b64 exec, s[58:59]
    v_and_or_b32 v188, v55, 32, v30
    ds_add_rtn_u32 v188, v188, v27
    s_mov_b64 exec, -1
    v_and_b32 v185, 63, v54
    v_bfe_u32 v187, v54, 6, 12
    v_mad_u32_u24 v185, v185, s48, v31
    v_lshrrev_b32 v186, 18, v54
    v_add_u32 v187, v187, v17
    v_and_b32 v189, 63, v55
    v_bfe_u32 v191, v55, 6, 12
    v_mad_u32_u24 v189, v189, s48, v31
    v_lshrrev_b32 v190, 18, v55
    v_add_u32 v191, v191, v17
    s_waitcnt lgkmcnt(0)
    s_mov_b64 exec, s[56:57]
    v_add_u32 v185, v185, v184
    v_lshl_add_u32 v184, v184, 2, v32
    ds_write_b16 v185, v28
    ds_write_b64 v184, v[186:187]
    s_mov_b64 exec, s[58:59]
    v_add_u32 v189, v189, v188
    v_lshl_add_u32 v188, v188, 2, v32
    ds_write_b16 v189, v28
    ds_write_b64 v188, v[190:191]
    s_mov_b64 exec, -1
L_placed:
    s_lshl_b32 s47, s41, 8
    v_add_u32 v56, s47, v16
    s_mul_i32 s47, s42, 3072
    s_add_u32 s47, s47, 81920
    s_sub_u32 s48, s47, s74
    v_add_u32 v6, s48, v12
    s_lshl_b32 s48, s41, 10
    s_add_u32 m0, s47, s48
    v_mov_b32 v113, v19
    v_mov_b32 v115, v19
    v_mov_b32 v117, v19
    v_mov_b32 v119, v19
    v_mov_b32 v121, v19
    v_mov_b32 v123, v19
    v_mov_b32 v124, 0x100000
    s_waitcnt lgkmcnt(0)
    s_barrier
    ds_read_b32 v22, v56 offset:4
    ds_read_b32 v112, v15 offset:0
    ds_read_b32 v114, v15 offset:128
    ds_read_b32 v116, v15 offset:256
    ds_read_b32 v118, v15 offset:384
    ds_read_b32 v120, v15 offset:512
    ds_read_b32 v122, v15 offset:640
    ds_read2_b32 v[52:53], v30 offset0:0 offset1:8
    ds_read_b32 v54, v30 offset:16
    s_waitcnt lgkmcnt(8)
    s_cmp_eq_u32 s41, 3
    s_cbranch_scc1 L_e_5
    buffer_load_dwordx4 v[22:23], s[8:11], 0 idxen offen lds
L_e_5:
    ds_read_b64_tr_b16 v[216:217], v36 offset:0
    ds_read_b64_tr_b16 v[218:219], v36 offset:1024
    ds_read_b64_tr_b16 v[220:221], v36 offset:4096
    ds_read_b64_tr_b16 v[222:223], v36 offset:5120
    ds_read_b64_tr_b16 v[224:225], v36 offset:8192
    ds_read_b64_tr_b16 v[226:227], v36 offset:9216
    ds_read_b64_tr_b16 v[228:229], v36 offset:12288
    ds_read_b64_tr_b16 v[230:231], v36 offset:13312
    ds_read_b64_tr_b16 v[232:233], v36 offset:16384
    ds_read_b64_tr_b16 v[234:235], v36 offset:17408
    ds_read_b64_tr_b16 v[236:237], v36 offset:20480
    ds_read_b64_tr_b16 v[238:239], v36 offset:21504
    ds_read_b64_tr_b16 v[240:241], v36 offset:24576
    ds_read_b64_tr_b16 v[242:243], v36 offset:25600
    ds_read_b64_tr_b16 v[244:245], v36 offset:28672
    ds_read_b64_tr_b16 v[246:247], v36 offset:29696
    s_waitcnt lgkmcnt(0)
    v_readfirstlane_b32 s66, v52
    v_readfirstlane_b32 s46, v53
    v_readfirstlane_b32 s67, v54
    s_sub_u32 s46, s46, 1152
    s_max_u32 s48, s66, s46
    s_cmp_eq_u32 s42, 0
    s_cselect_b32 s66, s66, s46
    v_mfma_f32_32x32x16_bf16 v[96:111], v[216:219], v[144:147], 0
    v_mov_b32 v80, 0
    v_mov_b32 v81, 0
    v_mfma_f32_32x32x16_bf16 v[96:111], v[220:223], v[148:151], v[96:111]
    v_mov_b32 v82, 0
    v_mov_b32 v83, 0
    v_mfma_f32_32x32x16_bf16 v[96:111], v[224:227], v[152:155], v[96:111]
    v_mov_b32 v84, 0
    v_mov_b32 v85, 0
    v_mfma_f32_32x32x16_bf16 v[96:111], v[228:231], v[156:159], v[96:111]
    v_mov_b32 v86, 0
    v_mov_b32 v87, 0
    v_mfma_f32_32x32x16_bf16 v[96:111], v[232:235], v[160:163], v[96:111]
    v_mov_b32 v88, 0
    v_mov_b32 v89, 0
    v_mfma_f32_32x32x16_bf16 v[96:111], v[236:239], v[164:167], v[96:111]
    v_mov_b32 v90, 0
    v_mov_b32 v91, 0
    v_mfma_f32_32x32x16_bf16 v[96:111], v[240:243], v[168:171], v[96:111]
    v_mov_b32 v92, 0
    v_mov_b32 v93, 0
    v_mfma_f32_32x32x16_bf16 v[96:111], v[244:247], v[172:175], v[96:111]
    v_mov_b32 v94, 0
    v_mov_b32 v95, 0
    s_cmp_lg_u32 s41, 3
    s_cbranch_scc1 L_nofl_6
    s_mov_b64 exec, -1
    buffer_load_dword v42, v43, s[32:35], s77 offen sc1
    s_mov_b64 exec, 0x7fff
    buffer_load_dword v44, v45, s[32:35], s77 offen sc1
    s_mov_b64 exec, -1
L_nofl_6:
    v_mov_b32 v7, v13
    v_mov_b32 v8, v14
    v_mov_b32 v9, v15
    v_mov_b32 v10, v16
    v_mov_b32 v194, 0
    v_mov_b32 v195, 0
    v_mov_b32 v160, 0
    v_mov_b32 v204, 0
    v_mov_b32 v161, 0
    v_mov_b32 v205, 0
    v_mov_b32 v162, 0
    v_mov_b32 v206, 0
    v_mov_b32 v163, 0
    v_mov_b32 v207, 0
    v_mov_b32 v164, 0
    v_mov_b32 v208, 0
    v_mov_b32 v165, 0
    v_mov_b32 v209, 0
    v_mov_b32 v166, 0
    v_mov_b32 v210, 0
    v_mov_b32 v167, 0
    v_mov_b32 v211, 0
    v_mov_b32 v168, 0
    v_mov_b32 v169, 0
    v_mov_b32 v170, 0
    v_mov_b32 v171, 0
    v_mov_b32 v172, 0
    v_mov_b32 v173, 0
    v_mov_b32 v174, 0
    v_mov_b32 v175, 0
    v_mov_b32 v176, 0
    v_mov_b32 v177, 0
    v_mov_b32 v178, 0
    v_mov_b32 v179, 0
    v_mov_b32 v180, 0
    v_mov_b32 v181, 0
    v_mov_b32 v182, 0
    v_mov_b32 v183, 0
    v_pk_mul_f32 v[96:97], v[96:97], s[52:53]
    v_pk_mul_f32 v[98:99], v[98:99], s[52:53]
    v_pk_mul_f32 v[100:101], v[100:101], s[52:53]
    v_pk_mul_f32 v[102:103], v[102:103], s[52:53]
    v_pk_mul_f32 v[104:105], v[104:105], s[52:53]
    v_pk_mul_f32 v[106:107], v[106:107], s[52:53]
    v_pk_mul_f32 v[108:109], v[108:109], s[52:53]
    v_pk_mul_f32 v[110:111], v[110:111], s[52:53]
    s_cmp_lg_u32 s41, 3
    s_waitcnt vmcnt(0)
    s_cbranch_scc1 L_fgot
L_fpoll:
    v_cmp_ne_u32 s[56:57], s44, v42
    v_cmp_ne_u32 s[58:59], s44, v44
    s_or_b64 vcc, s[56:57], s[58:59]
    s_cbranch_vccnz L_fnotyet
L_fgot:
    s_barrier
    s_add_u32 m0, s72, 0
    s_nop 0
    buffer_load_dwordx4 v[112:113], s[36:39], 0 idxen offen lds
    s_add_u32 m0, s72, 1024
    s_nop 0
    buffer_load_dwordx4 v[114:115], s[36:39], 0 idxen offen lds
    ds_read_b64_tr_b16 v[216:217], v37 offset:0
    ds_read_b64_tr_b16 v[218:219], v37 offset:2048
    ds_read_b64_tr_b16 v[220:221], v37 offset:4096
    ds_read_b64_tr_b16 v[222:223], v37 offset:6144
    ds_read_b64_tr_b16 v[224:225], v37 offset:8192
    ds_read_b64_tr_b16 v[226:227], v37 offset:10240
    ds_read_b64_tr_b16 v[228:229], v37 offset:12288
    ds_read_b64_tr_b16 v[230:231], v37 offset:14336
    ds_read_b64_tr_b16 v[232:233], v37 offset:16384
    ds_read_b64_tr_b16 v[234:235], v37 offset:18432
    ds_read_b64_tr_b16 v[236:237], v37 offset:20480
    ds_read_b64_tr_b16 v[238:239], v37 offset:22528
    ds_read_b64_tr_b16 v[240:241], v37 offset:24576
    ds_read_b64_tr_b16 v[242:243], v37 offset:26624
    ds_read_b64_tr_b16 v[244:245], v37 offset:28672
    ds_read_b64_tr_b16 v[246:247], v37 offset:30720
    s_add_u32 m0, s72, 2048
    s_nop 0
    buffer_load_dwordx4 v[116:117], s[36:39], 0 idxen offen lds
    s_add_u32 m0, s72, 3072
    s_nop 0
    buffer_load_dwordx4 v[118:119], s[36:39], 0 idxen offen lds
    s_add_u32 m0, s72, 4096
    s_nop 0
    buffer_load_dwordx4 v[120:121], s[36:39], 0 idxen offen lds
    s_add_u32 m0, s72, 5120
    s_nop 0
    buffer_load_dwordx4 v[122:123], s[36:39], 0 idxen offen lds
    buffer_load_dword v4, v124, s[8:11], 0 idxen
    s_cmp_gt_u32 s48, 896
    s_cbranch_scc1 L_slow
    s_cmp_lg_u32 s67, 0
    s_cbranch_scc1 L_slow
L_process:
    s_add_u32 s66, s66, 63
    s_lshr_b32 s66, s66, 6
    s_cmp_eq_u32 s66, 0
    s_cbranch_scc1 L_loopdone
    ds_read_b32 v18, v9 offset:768
    ds_read_b32 v20, v9 offset:896
    ds_read_b32 v22, v10 offset:772
    ds_read_b64_tr_b16 v[188:189], v8 offset:0
    ds_read_b64_tr_b16 v[190:191], v8 offset:7296
    ds_read_b64_tr_b16 v[192:193], v8 offset:14592
    s_mov_b32 s67, s66
    s_waitcnt vmcnt(5)
    ds_read_b128 v[184:187], v6 offset:0
    ds_read_u16_d16_hi v168, v11 offset:0
    ds_read_u16_d16_hi v169, v11 offset:64
    ds_read_u16_d16_hi v170, v11 offset:128
    ds_read_u16_d16_hi v171, v11 offset:192
    ds_read_u16_d16_hi v172, v11 offset:512
    ds_read_u16_d16_hi v173, v11 offset:576
    ds_read_u16_d16_hi v174, v11 offset:640
    ds_read_u16_d16_hi v175, v11 offset:704
    ds_read_u16_d16_hi v176, v11 offset:1024
    ds_read_u16_d16_hi v177, v11 offset:1088
    ds_read_u16_d16_hi v178, v11 offset:1152
    ds_read_u16_d16_hi v179, v11 offset:1216
    ds_read_u16_d16_hi v180, v11 offset:1536
    ds_read_u16_d16_hi v181, v11 offset:1600
    ds_read_u16_d16_hi v182, v11 offset:1664
    ds_read_u16_d16_hi v183, v11 offset:1728
    s_waitcnt lgkmcnt(0)
    v_mfma_f32_32x32x16_bf16 v[112:127], v[184:187], v[68:71], v[168:183]
    v_mfma_f32_32x32x16_bf16 v[112:127], v[188:191], v[72:75], v[112:127]
    v_mfma_f32_32x32x16_bf16 v[112:127], v[192:195], v[76:79], v[112:127]
.p2align 6
L_loop:
    s_waitcnt lgkmcnt(0)
    ds_read_b64_tr_b16 v[188:189], v8 offset:64
    ds_read_b64_tr_b16 v[190:191], v8 offset:7360
    ds_read_b64_tr_b16 v[192:193], v8 offset:14656
    s_waitcnt vmcnt(3)
    ds_read_b128 v[184:187], v6 offset:1024
    ds_read_u16_d16_hi v168, v11 offset:2048
    ds_read_u16_d16_hi v169, v11 offset:2112
    ds_read_u16_d16_hi v170, v11 offset:2176
    ds_read_u16_d16_hi v171, v11 offset:2240
    ds_read_u16_d16_hi v172, v11 offset:2560
    ds_read_u16_d16_hi v173, v11 offset:2624
    ds_read_u16_d16_hi v174, v11 offset:2688
    ds_read_u16_d16_hi v175, v11 offset:2752
    ds_read_u16_d16_hi v176, v11 offset:3072
    ds_read_u16_d16_hi v177, v11 offset:3136
    ds_read_u16_d16_hi v178, v11 offset:3200
    ds_read_u16_d16_hi v179, v11 offset:3264
    ds_read_u16_d16_hi v180, v11 offset:3584
    ds_read_u16_d16_hi v181, v11 offset:3648
    ds_read_u16_d16_hi v182, v11 offset:3712
    ds_read_u16_d16_hi v183, v11 offset:3776
    s_add_u32 m0, s74, 0
    s_nop 0
    buffer_load_dwordx4 v[22:23], s[8:11], 0 idxen offen lds
    s_add_u32 m0, s72, 0
    s_nop 0
    buffer_load_dwordx4 v[18:19], s[36:39], 0 idxen offen lds
    s_add_u32 m0, s72, 1024
    s_nop 0
    buffer_load_dwordx4 v[20:21], s[36:39], 0 idxen offen lds
    ds_read_b128 v[196:199], v7 offset:0
    ds_read_b128 v[200:203], v7 offset:32
    ds_read_b32 v18, v9 offset:1024
    ds_read_b32 v20, v9 offset:1152
    ds_read_b32 v22, v10 offset:1028
    s_waitcnt lgkmcnt(5)
    s_setprio 0
    v_exp_f32 v144, v112
    v_exp_f32 v145, v113
    s_setprio 1
    v_mfma_f32_32x32x16_bf16 v[80:95], v[160:163], v[204:207], v[80:95]
    v_exp_f32 v146, v114
    v_exp_f32 v147, v115
    v_exp_f32 v148, v116
    v_exp_f32 v149, v117
    v_mfma_f32_32x32x16_bf16 v[80:95], v[164:167], v[208:211], v[80:95]
    v_exp_f32 v150, v118
    v_exp_f32 v151, v119
    v_exp_f32 v152, v120
    v_exp_f32 v153, v121
    v_exp_f32 v154, v122
    v_exp_f32 v155, v123
    v_exp_f32 v156, v124
    v_exp_f32 v157, v125
    v_exp_f32 v158, v126
    v_exp_f32 v159, v127
    v_pk_add_f32 v[144:145], v[144:145], 1.0 op_sel_hi:[1,0]
    v_pk_add_f32 v[146:147], v[146:147], 1.0 op_sel_hi:[1,0]
    v_pk_add_f32 v[148:149], v[148:149], 1.0 op_sel_hi:[1,0]
    v_pk_add_f32 v[150:151], v[150:151], 1.0 op_sel_hi:[1,0]
    v_pk_add_f32 v[152:153], v[152:153], 1.0 op_sel_hi:[1,0]
    v_pk_add_f32 v[154:155], v[154:155], 1.0 op_sel_hi:[1,0]
    v_pk_add_f32 v[156:157], v[156:157], 1.0 op_sel_hi:[1,0]
    v_pk_add_f32 v[158:159], v[158:159], 1.0 op_sel_hi:[1,0]
    s_setprio 2
    v_mfma_f32_32x32x16_bf16 v[128:143], v[184:187], v[68:71], v[168:183]
    v_rcp_f32 v144, v144
    v_rcp_f32 v145, v145
    v_rcp_f32 v146, v146
    v_rcp_f32 v147, v147
    v_mfma_f32_32x32x16_bf16 v[128:143], v[188:191], v[72:75], v[128:143]
    v_rcp_f32 v148, v148
    v_rcp_f32 v149, v149
    v_rcp_f32 v150, v150
    v_rcp_f32 v151, v151
    v_mfma_f32_32x32x16_bf16 v[128:143], v[192:195], v[76:79], v[128:143]
    v_rcp_f32 v152, v152
    v_rcp_f32 v153, v153
    v_rcp_f32 v154, v154
    v_rcp_f32 v155, v155
    v_rcp_f32 v156, v156
    v_rcp_f32 v157, v157
    v_rcp_f32 v158, v158
    v_rcp_f32 v159, v159
    v_pk_mul_f32 v[144:145], v[144:145], v[112:113]
    v_pk_mul_f32 v[146:147], v[146:147], v[114:115]
    v_pk_mul_f32 v[148:149], v[148:149], v[116:117]
    v_pk_mul_f32 v[150:151], v[150:151], v[118:119]
    v_pk_mul_f32 v[152:153], v[152:153], v[120:121]
    v_pk_mul_f32 v[154:155], v[154:155], v[122:123]
    v_pk_mul_f32 v[156:157], v[156:157], v[124:125]
    v_pk_mul_f32 v[158:159], v[158:159], v[126:127]
    v_cvt_pk_bf16_f32 v160, v144, v145
    v_cvt_pk_bf16_f32 v161, v146, v147
    v_cvt_pk_bf16_f32 v162, v148, v149
    v_cvt_pk_bf16_f32 v163, v150, v151
    v_cvt_pk_bf16_f32 v164, v152, v153
    v_cvt_pk_bf16_f32 v165, v154, v155
    v_cvt_pk_bf16_f32 v166, v156, v157
    v_cvt_pk_bf16_f32 v167, v158, v159
    s_setprio 3
    s_sub_u32 s67, s67, 1
    s_cmp_eq_u32 s67, 0
    s_cbranch_scc1 L_exit0
    s_waitcnt lgkmcnt(0)
    ds_read_b64_tr_b16 v[188:189], v8 offset:128
    ds_read_b64_tr_b16 v[190:191], v8 offset:7424
    ds_read_b64_tr_b16 v[192:193], v8 offset:14720
    s_waitcnt vmcnt(3)
    ds_read_b128 v[184:187], v6 offset:2048
    ds_read_u16_d16_hi v168, v11 offset:4096
    ds_read_u16_d16_hi v169, v11 offset:4160
    ds_read_u16_d16_hi v170, v11 offset:4224
    ds_read_u16_d16_hi v171, v11 offset:4288
    ds_read_u16_d16_hi v172, v11 offset:4608
    ds_read_u16_d16_hi v173, v11 offset:4672
    ds_read_u16_d16_hi v174, v11 offset:4736
    ds_read_u16_d16_hi v175, v11 offset:4800
    ds_read_u16_d16_hi v176, v11 offset:5120
    ds_read_u16_d16_hi v177, v11 offset:5184
    ds_read_u16_d16_hi v178, v11 offset:5248
    ds_read_u16_d16_hi v179, v11 offset:5312
    ds_read_u16_d16_hi v180, v11 offset:5632
    ds_read_u16_d16_hi v181, v11 offset:5696
    ds_read_u16_d16_hi v182, v11 offset:5760
    ds_read_u16_d16_hi v183, v11 offset:5824
    s_add_u32 m0, s74, 1024
    s_nop 0
    buffer_load_dwordx4 v[22:23], s[8:11], 0 idxen offen lds
    s_add_u32 m0, s72, 2048
    s_nop 0
    buffer_load_dwordx4 v[18:19], s[36:39], 0 idxen offen lds
    s_add_u32 m0, s72, 3072
    s_nop 0
    buffer_load_dwordx4 v[20:21], s[36:39], 0 idxen offen lds
    ds_read_b128 v[204:207], v7 offset:64
    ds_read_b128 v[208:211], v7 offset:96
    ds_read_b32 v18, v9 offset:1280
    ds_read_b32 v20, v9 offset:1408
    ds_read_b32 v22, v10 offset:1284
    s_waitcnt lgkmcnt(5)
    s_setprio 0
    v_exp_f32 v144, v128
    v_exp_f32 v145, v129
    s_setprio 1
    v_mfma_f32_32x32x16_bf16 v[80:95], v[160:163], v[196:199], v[80:95]
    v_exp_f32 v146, v130
    v_exp_f32 v147, v131
    v_exp_f32 v148, v132
    v_exp_f32 v149, v133
    v_mfma_f32_32x32x16_bf16 v[80:95], v[164:167], v[200:203], v[80:95]
    v_exp_f32 v150, v134
    v_exp_f32 v151, v135
    v_exp_f32 v152, v136
    v_exp_f32 v153, v137
    v_exp_f32 v154, v138
    v_exp_f32 v155, v139
    v_exp_f32 v156, v140
    v_exp_f32 v157, v141
    v_exp_f32 v158, v142
    v_exp_f32 v159, v143
    v_pk_add_f32 v[144:145], v[144:145], 1.0 op_sel_hi:[1,0]
    v_pk_add_f32 v[146:147], v[146:147], 1.0 op_sel_hi:[1,0]
    v_pk_add_f32 v[148:149], v[148:149], 1.0 op_sel_hi:[1,0]
    v_pk_add_f32 v[150:151], v[150:151], 1.0 op_sel_hi:[1,0]
    v_pk_add_f32 v[152:153], v[152:153], 1.0 op_sel_hi:[1,0]
    v_pk_add_f32 v[154:155], v[154:155], 1.0 op_sel_hi:[1,0]
    v_pk_add_f32 v[156:157], v[156:157], 1.0 op_sel_hi:[1,0]
    v_pk_add_f32 v[158:159], v[158:159], 1.0 op_sel_hi:[1,0]
    s_setprio 2
    v_mfma_f32_32x32x16_bf16 v[112:127], v[184:187], v[68:71], v[168:183]
    v_rcp_f32 v144, v144
    v_rcp_f32 v145, v145
    v_rcp_f32 v146, v146
    v_rcp_f32 v147, v147
    v_mfma_f32_32x32x16_bf16 v[112:127], v[188:191], v[72:75], v[112:127]
    v_rcp_f32 v148, v148
    v_rcp_f32 v149, v149
    v_rcp_f32 v150, v150
    v_rcp_f32 v151, v151
    v_mfma_f32_32x32x16_bf16 v[112:127], v[192:195], v[76:79], v[112:127]
    v_rcp_f32 v152, v152
    v_rcp_f32 v153, v153
    v_rcp_f32 v154, v154
    v_rcp_f32 v155, v155
    v_rcp_f32 v156, v156
    v_rcp_f32 v157, v157
    v_rcp_f32 v158, v158
    v_rcp_f32 v159, v159
    v_pk_mul_f32 v[144:145], v[144:145], v[128:129]
    v_pk_mul_f32 v[146:147], v[146:147], v[130:131]
    v_pk_mul_f32 v[148:149], v[148:149], v[132:133]
    v_pk_mul_f32 v[150:151], v[150:151], v[134:135]
    v_pk_mul_f32 v[152:153], v[152:153], v[136:137]
    v_pk_mul_f32 v[154:155], v[154:155], v[138:139]
    v_pk_mul_f32 v[156:157], v[156:157], v[140:141]
    v_pk_mul_f32 v[158:159], v[158:159], v[142:143]
    v_cvt_pk_bf16_f32 v160, v144, v145
    v_cvt_pk_bf16_f32 v161, v146, v147
    v_cvt_pk_bf16_f32 v162, v148, v149
    v_cvt_pk_bf16_f32 v163, v150, v151
    v_cvt_pk_bf16_f32 v164, v152, v153
    v_cvt_pk_bf16_f32 v165, v154, v155
    v_cvt_pk_bf16_f32 v166, v156, v157
    v_cvt_pk_bf16_f32 v167, v158, v159
    s_setprio 3
    s_sub_u32 s67, s67, 1
    s_cmp_eq_u32 s67, 0
    s_cbranch_scc1 L_exit1
    s_waitcnt lgkmcnt(0)
    ds_read_b64_tr_b16 v[188:189], v8 offset:192
    ds_read_b64_tr_b16 v[190:191], v8 offset:7488
    ds_read_b64_tr_b16 v[192:193], v8 offset:14784
    s_waitcnt vmcnt(3)
    ds_read_b128 v[184:187], v12 offset:0
    ds_read_u16_d16_hi v168, v11 offset:0
    ds_read_u16_d16_hi v169, v11 offset:64
    ds_read_u16_d16_hi v170, v11 offset:128
    ds_read_u16_d16_hi v171, v11 offset:192
    ds_read_u16_d16_hi v172, v11 offset:512
    ds_read_u16_d16_hi v173, v11 offset:576
    ds_read_u16_d16_hi v174, v11 offset:640
    ds_read_u16_d16_hi v175, v11 offset:704
    ds_read_u16_d16_hi v176, v11 offset:1024
    ds_read_u16_d16_hi v177, v11 offset:1088
    ds_read_u16_d16_hi v178, v11 offset:1152
    ds_read_u16_d16_hi v179, v11 offset:1216
    ds_read_u16_d16_hi v180, v11 offset:1536
    ds_read_u16_d16_hi v181, v11 offset:1600
    ds_read_u16_d16_hi v182, v11 offset:1664
    ds_read_u16_d16_hi v183, v11 offset:1728
    s_add_u32 m0, s74, 2048
    s_nop 0
    buffer_load_dwordx4 v[22:23], s[8:11], 0 idxen offen lds
    s_add_u32 m0, s72, 4096
    s_nop 0
    buffer_load_dwordx4 v[18:19], s[36:39], 0 idxen offen lds
    s_add_u32 m0, s72, 5120
    s_nop 0
    buffer_load_dwordx4 v[20:21], s[36:39], 0 idxen offen lds
    ds_read_b128 v[196:199], v7 offset:128
    ds_read_b128 v[200:203], v7 offset:160
    ds_read_b32 v18, v9 offset:1536
    ds_read_b32 v20, v9 offset:1664
    ds_read_b32 v22, v10 offset:1540
    s_waitcnt lgkmcnt(5)
    s_setprio 0
    v_exp_f32 v144, v112
    v_exp_f32 v145, v113
    s_setprio 1
    v_mfma_f32_32x32x16_bf16 v[80:95], v[160:163], v[204:207], v[80:95]
    v_exp_f32 v146, v114
    v_exp_f32 v147, v115
    v_exp_f32 v148, v116
    v_exp_f32 v149, v117
    v_mfma_f32_32x32x16_bf16 v[80:95], v[164:167], v[208:211], v[80:95]
    v_exp_f32 v150, v118
    v_exp_f32 v151, v119
    v_exp_f32 v152, v120
    v_exp_f32 v153, v121
    v_exp_f32 v154, v122
    v_exp_f32 v155, v123
    v_exp_f32 v156, v124
    v_exp_f32 v157, v125
    v_exp_f32 v158, v126
    v_exp_f32 v159, v127
    v_pk_add_f32 v[144:145], v[144:145], 1.0 op_sel_hi:[1,0]
    v_pk_add_f32 v[146:147], v[146:147], 1.0 op_sel_hi:[1,0]
    v_pk_add_f32 v[148:149], v[148:149], 1.0 op_sel_hi:[1,0]
    v_pk_add_f32 v[150:151], v[150:151], 1.0 op_sel_hi:[1,0]
    v_pk_add_f32 v[152:153], v[152:153], 1.0 op_sel_hi:[1,0]
    v_pk_add_f32 v[154:155], v[154:155], 1.0 op_sel_hi:[1,0]
    v_pk_add_f32 v[156:157], v[156:157], 1.0 op_sel_hi:[1,0]
    v_pk_add_f32 v[158:159], v[158:159], 1.0 op_sel_hi:[1,0]
    s_setprio 2
    v_mfma_f32_32x32x16_bf16 v[128:143], v[184:187], v[68:71], v[168:183]
    v_rcp_f32 v144, v144
    v_rcp_f32 v145, v145
    v_rcp_f32 v146, v146
    v_rcp_f32 v147, v147
    v_mfma_f32_32x32x16_bf16 v[128:143], v[188:191], v[72:75], v[128:143]
    v_rcp_f32 v148, v148
    v_rcp_f32 v149, v149
    v_rcp_f32 v150, v150
    v_rcp_f32 v151, v151
    v_mfma_f32_32x32x16_bf16 v[128:143], v[192:195], v[76:79], v[128:143]
    v_rcp_f32 v152, v152
    v_rcp_f32 v153, v153
    v_rcp_f32 v154, v154
    v_rcp_f32 v155, v155
    v_rcp_f32 v156, v156
    v_rcp_f32 v157, v157
    v_rcp_f32 v158, v158
    v_rcp_f32 v159, v159
    v_pk_mul_f32 v[144:145], v[144:145], v[112:113]
    v_pk_mul_f32 v[146:147], v[146:147], v[114:115]
    v_pk_mul_f32 v[148:149], v[148:149], v[116:117]
    v_pk_mul_f32 v[150:151], v[150:151], v[118:119]
    v_pk_mul_f32 v[152:153], v[152:153], v[120:121]
    v_pk_mul_f32 v[154:155], v[154:155], v[122:123]
    v_pk_mul_f32 v[156:157], v[156:157], v[124:125]
    v_pk_mul_f32 v[158:159], v[158:159], v[126:127]
    v_cvt_pk_bf16_f32 v160, v144, v145
    v_cvt_pk_bf16_f32 v161, v146, v147
    v_cvt_pk_bf16_f32 v162, v148, v149
    v_cvt_pk_bf16_f32 v163, v150, v151
    v_cvt_pk_bf16_f32 v164, v152, v153
    v_cvt_pk_bf16_f32 v165, v154, v155
    v_cvt_pk_bf16_f32 v166, v156, v157
    v_cvt_pk_bf16_f32 v167, v158, v159
    s_setprio 3
    s_sub_u32 s67, s67, 1
    s_cmp_eq_u32 s67, 0
    s_cbranch_scc1 L_exit0
    s_waitcnt lgkmcnt(0)
    ds_read_b64_tr_b16 v[188:189], v8 offset:256
    ds_read_b64_tr_b16 v[190:191], v8 offset:7552
    ds_read_b64_tr_b16 v[192:193], v8 offset:14848
    s_waitcnt vmcnt(3)
    ds_read_b128 v[184:187], v12 offset:1024
    ds_read_u16_d16_hi v168, v11 offset:2048
    ds_read_u16_d16_hi v169, v11 offset:2112
    ds_read_u16_d16_hi v170, v11 offset:2176
    ds_read_u16_d16_hi v171, v11 offset:2240
    ds_read_u16_d16_hi v172, v11 offset:2560
    ds_read_u16_d16_hi v173, v11 offset:2624
    ds_read_u16_d16_hi v174, v11 offset:2688
    ds_read_u16_d16_hi v175, v11 offset:2752
    ds_read_u16_d16_hi v176, v11 offset:3072
    ds_read_u16_d16_hi v177, v11 offset:3136
    ds_read_u16_d16_hi v178, v11 offset:3200
    ds_read_u16_d16_hi v179, v11 offset:3264
    ds_read_u16_d16_hi v180, v11 offset:3584
    ds_read_u16_d16_hi v181, v11 offset:3648
    ds_read_u16_d16_hi v182, v11 offset:3712
    ds_read_u16_d16_hi v183, v11 offset:3776
    s_add_u32 m0, s74, 0
    s_nop 0
    buffer_load_dwordx4 v[22:23], s[8:11], 0 idxen offen lds
    s_add_u32 m0, s72, 0
    s_nop 0
    buffer_load_dwordx4 v[18:19], s[36:39], 0 idxen offen lds
    s_add_u32 m0, s72, 1024
    s_nop 0
    buffer_load_dwordx4 v[20:21], s[36:39], 0 idxen offen lds
    ds_read_b128 v[204:207], v7 offset:192
    ds_read_b128 v[208:211], v7 offset:224
    ds_read_b32 v18, v9 offset:1792
    ds_read_b32 v20, v9 offset:1920
    ds_read_b32 v22, v10 offset:1796
    s_waitcnt lgkmcnt(5)
    s_setprio 0
    v_exp_f32 v144, v128
    v_exp_f32 v145, v129
    s_setprio 1
    v_mfma_f32_32x32x16_bf16 v[80:95], v[160:163], v[196:199], v[80:95]
    v_exp_f32 v146, v130
    v_exp_f32 v147, v131
    v_exp_f32 v148, v132
    v_exp_f32 v149, v133
    v_mfma_f32_32x32x16_bf16 v[80:95], v[164:167], v[200:203], v[80:95]
    v_exp_f32 v150, v134
    v_exp_f32 v151, v135
    v_exp_f32 v152, v136
    v_exp_f32 v153, v137
    v_exp_f32 v154, v138
    v_exp_f32 v155, v139
    v_exp_f32 v156, v140
    v_exp_f32 v157, v141
    v_exp_f32 v158, v142
    v_exp_f32 v159, v143
    v_pk_add_f32 v[144:145], v[144:145], 1.0 op_sel_hi:[1,0]
    v_pk_add_f32 v[146:147], v[146:147], 1.0 op_sel_hi:[1,0]
    v_pk_add_f32 v[148:149], v[148:149], 1.0 op_sel_hi:[1,0]
    v_pk_add_f32 v[150:151], v[150:151], 1.0 op_sel_hi:[1,0]
    v_pk_add_f32 v[152:153], v[152:153], 1.0 op_sel_hi:[1,0]
    v_pk_add_f32 v[154:155], v[154:155], 1.0 op_sel_hi:[1,0]
    v_pk_add_f32 v[156:157], v[156:157], 1.0 op_sel_hi:[1,0]
    v_pk_add_f32 v[158:159], v[158:159], 1.0 op_sel_hi:[1,0]
    s_setprio 2
    v_mfma_f32_32x32x16_bf16 v[112:127], v[184:187], v[68:71], v[168:183]
    v_rcp_f32 v144, v144
    v_rcp_f32 v145, v145
    v_rcp_f32 v146, v146
    v_rcp_f32 v147, v147
    v_mfma_f32_32x32x16_bf16 v[112:127], v[188:191], v[72:75], v[112:127]
    v_rcp_f32 v148, v148
    v_rcp_f32 v149, v149
    v_rcp_f32 v150, v150
    v_rcp_f32 v151, v151
    v_mfma_f32_32x32x16_bf16 v[112:127], v[192:195], v[76:79], v[112:127]
    v_rcp_f32 v152, v152
    v_rcp_f32 v153, v153
    v_rcp_f32 v154, v154
    v_rcp_f32 v155, v155
    v_rcp_f32 v156, v156
    v_rcp_f32 v157, v157
    v_rcp_f32 v158, v158
    v_rcp_f32 v159, v159
    v_pk_mul_f32 v[144:145], v[144:145], v[128:129]
    v_pk_mul_f32 v[146:147], v[146:147], v[130:131]
    v_pk_mul_f32 v[148:149], v[148:149], v[132:133]
    v_pk_mul_f32 v[150:151], v[150:151], v[134:135]
    v_pk_mul_f32 v[152:153], v[152:153], v[136:137]
    v_pk_mul_f32 v[154:155], v[154:155], v[138:139]
    v_pk_mul_f32 v[156:157], v[156:157], v[140:141]
    v_pk_mul_f32 v[158:159], v[158:159], v[142:143]
    v_cvt_pk_bf16_f32 v160, v144, v145
    v_cvt_pk_bf16_f32 v161, v146, v147
    v_cvt_pk_bf16_f32 v162, v148, v149
    v_cvt_pk_bf16_f32 v163, v150, v151
    v_cvt_pk_bf16_f32 v164, v152, v153
    v_cvt_pk_bf16_f32 v165, v154, v155
    v_cvt_pk_bf16_f32 v166, v156, v157
    v_cvt_pk_bf16_f32 v167, v158, v159
    s_setprio 3
    s_sub_u32 s67, s67, 1
    s_cmp_eq_u32 s67, 0
    s_cbranch_scc1 L_exit1
    s_waitcnt lgkmcnt(0)
    ds_read_b64_tr_b16 v[188:189], v8 offset:320
    ds_read_b64_tr_b16 v[190:191], v8 offset:7616
    ds_read_b64_tr_b16 v[192:193], v8 offset:14912
    s_waitcnt vmcnt(3)
    ds_read_b128 v[184:187], v12 offset:2048
    ds_read_u16_d16_hi v168, v11 offset:4096
    ds_read_u16_d16_hi v169, v11 offset:4160
    ds_read_u16_d16_hi v170, v11 offset:4224
    ds_read_u16_d16_hi v171, v11 offset:4288
    ds_read_u16_d16_hi v172, v11 offset:4608
    ds_read_u16_d16_hi v173, v11 offset:4672
    ds_read_u16_d16_hi v174, v11 offset:4736
    ds_read_u16_d16_hi v175, v11 offset:4800
    ds_read_u16_d16_hi v176, v11 offset:5120
    ds_read_u16_d16_hi v177, v11 offset:5184
    ds_read_u16_d16_hi v178, v11 offset:5248
    ds_read_u16_d16_hi v179, v11 offset:5312
    ds_read_u16_d16_hi v180, v11 offset:5632
    ds_read_u16_d16_hi v181, v11 offset:5696
    ds_read_u16_d16_hi v182, v11 offset:5760
    ds_read_u16_d16_hi v183, v11 offset:5824
    s_add_u32 m0, s74, 1024
    s_nop 0
    buffer_load_dwordx4 v[22:23], s[8:11], 0 idxen offen lds
    s_add_u32 m0, s72, 2048
    s_nop 0
    buffer_load_dwordx4 v[18:19], s[36:39], 0 idxen offen lds
    s_add_u32 m0, s72, 3072
    s_nop 0
    buffer_load_dwordx4 v[20:21], s[36:39], 0 idxen offen lds
    ds_read_b128 v[196:199], v7 offset:256
    ds_read_b128 v[200:203], v7 offset:288
    ds_read_b32 v18, v9 offset:2048
    ds_read_b32 v20, v9 offset:2176
    ds_read_b32 v22, v10 offset:2052
    s_waitcnt lgkmcnt(5)
    s_setprio 0
    v_exp_f32 v144, v112
    v_exp_f32 v145, v113
    s_setprio 1
    v_mfma_f32_32x32x16_bf16 v[80:95], v[160:163], v[204:207], v[80:95]
    v_exp_f32 v146, v114
    v_exp_f32 v147, v115
    v_exp_f32 v148, v116
    v_exp_f32 v149, v117
    v_mfma_f32_32x32x16_bf16 v[80:95], v[164:167], v[208:211], v[80:95]
    v_exp_f32 v150, v118
    v_exp_f32 v151, v119
    v_exp_f32 v152, v120
    v_exp_f32 v153, v121
    v_exp_f32 v154, v122
    v_exp_f32 v155, v123
    v_exp_f32 v156, v124
    v_exp_f32 v157, v125
    v_exp_f32 v158, v126
    v_exp_f32 v159, v127
    v_pk_add_f32 v[144:145], v[144:145], 1.0 op_sel_hi:[1,0]
    v_pk_add_f32 v[146:147], v[146:147], 1.0 op_sel_hi:[1,0]
    v_pk_add_f32 v[148:149], v[148:149], 1.0 op_sel_hi:[1,0]
    v_pk_add_f32 v[150:151], v[150:151], 1.0 op_sel_hi:[1,0]
    v_pk_add_f32 v[152:153], v[152:153], 1.0 op_sel_hi:[1,0]
    v_pk_add_f32 v[154:155], v[154:155], 1.0 op_sel_hi:[1,0]
    v_pk_add_f32 v[156:157], v[156:157], 1.0 op_sel_hi:[1,0]
    v_pk_add_f32 v[158:159], v[158:159], 1.0 op_sel_hi:[1,0]
    s_setprio 2
    v_mfma_f32_32x32x16_bf16 v[128:143], v[184:187], v[68:71], v[168:183]
    v_rcp_f32 v144, v144
    v_rcp_f32 v145, v145
    v_rcp_f32 v146, v146
    v_rcp_f32 v147, v147
    v_mfma_f32_32x32x16_bf16 v[128:143], v[188:191], v[72:75], v[128:143]
    v_rcp_f32 v148, v148
    v_rcp_f32 v149, v149
    v_rcp_f32 v150, v150
    v_rcp_f32 v151, v151
    v_mfma_f32_32x32x16_bf16 v[128:143], v[192:195], v[76:79], v[128:143]
    v_rcp_f32 v152, v152
    v_rcp_f32 v153, v153
    v_rcp_f32 v154, v154
    v_rcp_f32 v155, v155
    v_rcp_f32 v156, v156
    v_rcp_f32 v157, v157
    v_rcp_f32 v158, v158
    v_rcp_f32 v159, v159
    v_pk_mul_f32 v[144:145], v[144:145], v[112:113]
    v_pk_mul_f32 v[146:147], v[146:147], v[114:115]
    v_pk_mul_f32 v[148:149], v[148:149], v[116:117]
    v_pk_mul_f32 v[150:151], v[150:151], v[118:119]
    v_pk_mul_f32 v[152:153], v[152:153], v[120:121]
    v_pk_mul_f32 v[154:155], v[154:155], v[122:123]
    v_pk_mul_f32 v[156:157], v[156:157], v[124:125]
    v_pk_mul_f32 v[158:159], v[158:159], v[126:127]
    v_cvt_pk_bf16_f32 v160, v144, v145
    v_cvt_pk_bf16_f32 v161, v146, v147
    v_cvt_pk_bf16_f32 v162, v148, v149
    v_cvt_pk_bf16_f32 v163, v150, v151
    v_cvt_pk_bf16_f32 v164, v152, v153
    v_cvt_pk_bf16_f32 v165, v154, v155
    v_cvt_pk_bf16_f32 v166, v156, v157
    v_cvt_pk_bf16_f32 v167, v158, v159
    s_setprio 3
    s_sub_u32 s67, s67, 1
    s_cmp_eq_u32 s67, 0
    s_cbranch_scc1 L_exit0
    s_waitcnt lgkmcnt(0)
    ds_read_b64_tr_b16 v[188:189], v8 offset:384
    ds_read_b64_tr_b16 v[190:191], v8 offset:7680
    ds_read_b64_tr_b16 v[192:193], v8 offset:14976
    s_waitcnt vmcnt(3)
    ds_read_b128 v[184:187], v12 offset:0
    ds_read_u16_d16_hi v168, v11 offset:0
    ds_read_u16_d16_hi v169, v11 offset:64
    ds_read_u16_d16_hi v170, v11 offset:128
    ds_read_u16_d16_hi v171, v11 offset:192
    ds_read_u16_d16_hi v172, v11 offset:512
    ds_read_u16_d16_hi v173, v11 offset:576
    ds_read_u16_d16_hi v174, v11 offset:640
    ds_read_u16_d16_hi v175, v11 offset:704
    ds_read_u16_d16_hi v176, v11 offset:1024
    ds_read_u16_d16_hi v177, v11 offset:1088
    ds_read_u16_d16_hi v178, v11 offset:1152
    ds_read_u16_d16_hi v179, v11 offset:1216
    ds_read_u16_d16_hi v180, v11 offset:1536
    ds_read_u16_d16_hi v181, v11 offset:1600
    ds_read_u16_d16_hi v182, v11 offset:1664
    ds_read_u16_d16_hi v183, v11 offset:1728
    s_add_u32 m0, s74, 2048
    s_nop 0
    buffer_load_dwordx4 v[22:23], s[8:11], 0 idxen offen lds
    s_add_u32 m0, s72, 4096
    s_nop 0
    buffer_load_dwordx4 v[18:19], s[36:39], 0 idxen offen lds
    s_add_u32 m0, s72, 5120
    s_nop 0
    buffer_load_dwordx4 v[20:21], s[36:39], 0 idxen offen lds
    ds_read_b128 v[204:207], v7 offset:320
    ds_read_b128 v[208:211], v7 offset:352
    ds_read_b32 v18, v9 offset:2304
    ds_read_b32 v20, v9 offset:2432
    ds_read_b32 v22, v10 offset:2308
    v_mov_b32 v6, v12
    v_add_u32 v8, 384, v8
    v_add_u32 v7, 384, v7
    v_add_u32 v9, 1536, v9
    v_add_u32 v10, 1536, v10
    s_waitcnt lgkmcnt(5)
    s_setprio 0
    v_exp_f32 v144, v128
    v_exp_f32 v145, v129
    s_setprio 1
    v_mfma_f32_32x32x16_bf16 v[80:95], v[160:163], v[196:199], v[80:95]
    v_exp_f32 v146, v130
    v_exp_f32 v147, v131
    v_exp_f32 v148, v132
    v_exp_f32 v149, v133
    v_mfma_f32_32x32x16_bf16 v[80:95], v[164:167], v[200:203], v[80:95]
    v_exp_f32 v150, v134
    v_exp_f32 v151, v135
    v_exp_f32 v152, v136
    v_exp_f32 v153, v137
    v_exp_f32 v154, v138
    v_exp_f32 v155, v139
    v_exp_f32 v156, v140
    v_exp_f32 v157, v141
    v_exp_f32 v158, v142
    v_exp_f32 v159, v143
    v_pk_add_f32 v[144:145], v[144:145], 1.0 op_sel_hi:[1,0]
    v_pk_add_f32 v[146:147], v[146:147], 1.0 op_sel_hi:[1,0]
    v_pk_add_f32 v[148:149], v[148:149], 1.0 op_sel_hi:[1,0]
    v_pk_add_f32 v[150:151], v[150:151], 1.0 op_sel_hi:[1,0]
    v_pk_add_f32 v[152:153], v[152:153], 1.0 op_sel_hi:[1,0]
    v_pk_add_f32 v[154:155], v[154:155], 1.0 op_sel_hi:[1,0]
    v_pk_add_f32 v[156:157], v[156:157], 1.0 op_sel_hi:[1,0]
    v_pk_add_f32 v[158:159], v[158:159], 1.0 op_sel_hi:[1,0]
    s_setprio 2
    v_mfma_f32_32x32x16_bf16 v[112:127], v[184:187], v[68:71], v[168:183]
    v_rcp_f32 v144, v144
    v_rcp_f32 v145, v145
    v_rcp_f32 v146, v146
    v_rcp_f32 v147, v147
    v_mfma_f32_32x32x16_bf16 v[112:127], v[188:191], v[72:75], v[112:127]
    v_rcp_f32 v148, v148
    v_rcp_f32 v149, v149
    v_rcp_f32 v150, v150
    v_rcp_f32 v151, v151
    v_mfma_f32_32x32x16_bf16 v[112:127], v[192:195], v[76:79], v[112:127]
    v_rcp_f32 v152, v152
    v_rcp_f32 v153, v153
    v_rcp_f32 v154, v154
    v_rcp_f32 v155, v155
    v_rcp_f32 v156, v156
    v_rcp_f32 v157, v157
    v_rcp_f32 v158, v158
    v_rcp_f32 v159, v159
    v_pk_mul_f32 v[144:145], v[144:145], v[128:129]
    v_pk_mul_f32 v[146:147], v[146:147], v[130:131]
    v_pk_mul_f32 v[148:149], v[148:149], v[132:133]
    v_pk_mul_f32 v[150:151], v[150:151], v[134:135]
    v_pk_mul_f32 v[152:153], v[152:153], v[136:137]
    v_pk_mul_f32 v[154:155], v[154:155], v[138:139]
    v_pk_mul_f32 v[156:157], v[156:157], v[140:141]
    v_pk_mul_f32 v[158:159], v[158:159], v[142:143]
    v_cvt_pk_bf16_f32 v160, v144, v145
    v_cvt_pk_bf16_f32 v161, v146, v147
    v_cvt_pk_bf16_f32 v162, v148, v149
    v_cvt_pk_bf16_f32 v163, v150, v151
    v_cvt_pk_bf16_f32 v164, v152, v153
    v_cvt_pk_bf16_f32 v165, v154, v155
    v_cvt_pk_bf16_f32 v166, v156, v157
    v_cvt_pk_bf16_f32 v167, v158, v159
    s_setprio 3
    s_sub_u32 s67, s67, 1
    s_cmp_eq_u32 s67, 0
    s_cbranch_scc0 L_loop
L_exit1:
    s_waitcnt lgkmcnt(0)
    v_mfma_f32_32x32x16_bf16 v[80:95], v[160:163], v[204:207], v[80:95]
    v_mfma_f32_32x32x16_bf16 v[80:95], v[164:167], v[208:211], v[80:95]
    s_branch L_loopdone
L_exit0:
    s_waitcnt lgkmcnt(0)
    v_mfma_f32_32x32x16_bf16 v[80:95], v[160:163], v[196:199], v[80:95]
    v_mfma_f32_32x32x16_bf16 v[80:95], v[164:167], v[200:203], v[80:95]
L_loopdone:
    s_cmp_lg_u32 s69, 0
    s_cbranch_scc1 L_slow_next
L_epi:
    s_waitcnt vmcnt(0)
    s_nop 7
    s_nop 1
    v_cvt_pk_bf16_f32 v196, v80, v81
    v_cvt_pk_bf16_f32 v197, v82, v83
    v_cvt_pk_bf16_f32 v198, v84, v85
    v_cvt_pk_bf16_f32 v199, v86, v87
    ds_write_b128 v46, v[196:199]
    v_cvt_pk_bf16_f32 v200, v88, v89
    v_cvt_pk_bf16_f32 v201, v90, v91
    v_cvt_pk_bf16_f32 v202, v92, v93
    v_cvt_pk_bf16_f32 v203, v94, v95
    ds_write_b128 v46, v[200:203] offset:1024
    s_waitcnt lgkmcnt(0)
    s_barrier
    ds_read_b128 v[112:115], v47 offset:0
    ds_read_b128 v[116:119], v47 offset:1024
    ds_read_b128 v[120:123], v47 offset:6144
    ds_read_b128 v[124:127], v47 offset:7168
    ds_read_b128 v[128:131], v47 offset:12288
    ds_read_b128 v[132:135], v47 offset:13312
    ds_read_b128 v[136:139], v47 offset:18432
    ds_read_b128 v[140:143], v47 offset:19456
    s_waitcnt lgkmcnt(7)
    v_mfma_f32_32x32x16_bf16 v[96:111], v[216:219], v[112:115], v[96:111]
    s_waitcnt lgkmcnt(6)
    v_mfma_f32_32x32x16_bf16 v[96:111], v[220:223], v[116:119], v[96:111]
    s_waitcnt lgkmcnt(5)
    v_mfma_f32_32x32x16_bf16 v[96:111], v[224:227], v[120:123], v[96:111]
    s_waitcnt lgkmcnt(4)
    v_mfma_f32_32x32x16_bf16 v[96:111], v[228:231], v[124:127], v[96:111]
    s_waitcnt lgkmcnt(3)
    v_mfma_f32_32x32x16_bf16 v[96:111], v[232:235], v[128:131], v[96:111]
    s_waitcnt lgkmcnt(2)
    v_mfma_f32_32x32x16_bf16 v[96:111], v[236:239], v[132:135], v[96:111]
    s_waitcnt lgkmcnt(1)
    v_mfma_f32_32x32x16_bf16 v[96:111], v[240:243], v[136:139], v[96:111]
    s_waitcnt lgkmcnt(0)
    v_mfma_f32_32x32x16_bf16 v[96:111], v[244:247], v[140:143], v[96:111]
    s_cmp_lg_u32 s40, 0
    s_cbranch_scc1 L_noep
    s_mov_b64 exec, 1
    s_add_u32 s43, s43, 1
    s_sub_u32 s45, s77, 0x10000
    v_mov_b32 v58, s43
    v_mov_b32 v59, 0
    buffer_store_dword v58, v59, s[32:35], s45 offen
    s_mov_b64 exec, -1
L_noep:
    s_nop 7
    s_nop 2
    v_exp_f32 v80, v96
    v_exp_f32 v81, v97
    v_exp_f32 v82, v98
    v_exp_f32 v83, v99
    v_exp_f32 v84, v100
    v_exp_f32 v85, v101
    v_exp_f32 v86, v102
    v_exp_f32 v87, v103
    v_pk_add_f32 v[80:81], v[80:81], 1.0 op_sel_hi:[1,0]
    v_pk_add_f32 v[82:83], v[82:83], 1.0 op_sel_hi:[1,0]
    v_pk_add_f32 v[84:85], v[84:85], 1.0 op_sel_hi:[1,0]
    v_pk_add_f32 v[86:87], v[86:87], 1.0 op_sel_hi:[1,0]
    v_pk_mul_f32 v[96:97], v[96:97], s[54:55]
    v_pk_mul_f32 v[98:99], v[98:99], s[54:55]
    v_pk_mul_f32 v[100:101], v[100:101], s[54:55]
    v_pk_mul_f32 v[102:103], v[102:103], s[54:55]
    v_rcp_f32 v80, v80
    v_rcp_f32 v81, v81
    v_rcp_f32 v82, v82
    v_rcp_f32 v83, v83
    v_rcp_f32 v84, v84
    v_rcp_f32 v85, v85
    v_rcp_f32 v86, v86
    v_rcp_f32 v87, v87
    v_pk_mul_f32 v[80:81], v[80:81], v[96:97]
    v_pk_mul_f32 v[82:83], v[82:83], v[98:99]
    v_pk_mul_f32 v[84:85], v[84:85], v[100:101]
    v_pk_mul_f32 v[86:87], v[86:87], v[102:103]
    v_cvt_pk_bf16_f32 v196, v80, v81
    v_cvt_pk_bf16_f32 v197, v82, v83
    v_cvt_pk_bf16_f32 v198, v84, v85
    v_cvt_pk_bf16_f32 v199, v86, v87
    buffer_store_dwordx4 v[196:199], v48, s[28:31], s78 offen offset:0
    v_exp_f32 v88, v104
    v_exp_f32 v89, v105
    v_exp_f32 v90, v106
    v_exp_f32 v91, v107
    v_exp_f32 v92, v108
    v_exp_f32 v93, v109
    v_exp_f32 v94, v110
    v_exp_f32 v95, v111
    v_pk_add_f32 v[88:89], v[88:89], 1.0 op_sel_hi:[1,0]
    v_pk_add_f32 v[90:91], v[90:91], 1.0 op_sel_hi:[1,0]
    v_pk_add_f32 v[92:93], v[92:93], 1.0 op_sel_hi:[1,0]
    v_pk_add_f32 v[94:95], v[94:95], 1.0 op_sel_hi:[1,0]
    v_pk_mul_f32 v[104:105], v[104:105], s[54:55]
    v_pk_mul_f32 v[106:107], v[106:107], s[54:55]
    v_pk_mul_f32 v[108:109], v[108:109], s[54:55]
    v_pk_mul_f32 v[110:111], v[110:111], s[54:55]
    v_rcp_f32 v88, v88
    v_rcp_f32 v89, v89
    v_rcp_f32 v90, v90
    v_rcp_f32 v91, v91
    v_rcp_f32 v92, v92
    v_rcp_f32 v93, v93
    v_rcp_f32 v94, v94
    v_rcp_f32 v95, v95
    v_pk_mul_f32 v[88:89], v[88:89], v[104:105]
    v_pk_mul_f32 v[90:91], v[90:91], v[106:107]
    v_pk_mul_f32 v[92:93], v[92:93], v[108:109]
    v_pk_mul_f32 v[94:95], v[94:95], v[110:111]
    v_cvt_pk_bf16_f32 v200, v88, v89
    v_cvt_pk_bf16_f32 v201, v90, v91
    v_cvt_pk_bf16_f32 v202, v92, v93
    v_cvt_pk_bf16_f32 v203, v94, v95
    buffer_store_dwordx4 v[200:203], v48, s[28:31], s78 offen offset:16
L_end:
    s_endpgm
L_notyet:
    v_cmp_lt_u32 vcc, 1, v58
    s_cbranch_vccz L_gotovf
    s_add_u32 s71, s71, 1
    s_cmp_lt_u32 s71, 0x8000
    s_cbranch_scc0 L_end
    s_mov_b64 exec, vcc
    buffer_load_dwordx4 v[52:55], v2, s[32:35], s76 offen sc1
    s_mov_b64 exec, -1
    s_waitcnt vmcnt(0)
    s_branch L_poll
L_gotovf:
    ds_write_b32 v30, v27 offset:16
    s_branch L_got
L_fnotyet:
    s_add_u32 s71, s71, 0x100
    s_cmp_lt_u32 s71, 0x800000
    s_cbranch_scc0 L_end
    s_or_b32 s56, s56, 1
    s_or_b32 s58, s58, 1
    s_mov_b64 exec, s[56:57]
    buffer_load_dword v42, v43, s[32:35], s77 offen sc1
    s_mov_b64 exec, s[58:59]
    buffer_load_dword v44, v45, s[32:35], s77 offen sc1
    s_mov_b64 exec, -1
    s_waitcnt vmcnt(0)
    s_branch L_fpoll
L_sort:
    s_mul_i32 s47, s49, 10000
    s_add_u32 s48, s47, 8192
    v_lshlrev_b32 v52, 2, v0
    s_mov_b32 s18, 0x9c400
    s_mov_b32 s19, 0x20000
    s_mov_b32 s14, 0x9c400
    s_mov_b32 s15, 0x20000
    s_waitcnt lgkmcnt(0)
    buffer_load_dwordx4 v[144:147], v2, s[16:19], s47 offen nt
    buffer_load_dwordx4 v[152:155], v2, s[12:15], s47 offen nt
    buffer_load_dword v148, v52, s[16:19], s48 offen nt
    buffer_load_dword v156, v52, s[12:15], s48 offen nt
    s_branch L_ent2
L_notpm:
    s_mov_b32 s18, 0x9c400
    s_mov_b32 s19, 0x20000
    s_mov_b32 s14, 0x9c400
    s_mov_b32 s15, 0x20000
    s_mov_b32 s34, 0x500000
    s_mov_b32 s35, 0x20000
    s_mov_b32 s26, 0x10000
    s_mov_b32 s27, 0x20000
    s_mov_b32 s30, 0x271000
    s_mov_b32 s31, 0x20000
    s_mov_b32 s10, 0x27100
    s_mov_b32 s11, 0x20000
    s_mov_b32 s38, 0x2710
    s_mov_b32 s39, 0x20000
    s_and_b32 s41, s40, 3
    s_lshr_b32 s42, s40, 2
    s_mov_b32 s62, 0x80808080
    s_mov_b32 s63, 0x80808080
    s_mov_b32 s52, 0xbfb8aa3b
    s_mov_b32 s53, 0xbfb8aa3b
    s_lshl_b32 s48, s2, 2
    s_add_u32 s77, s48, 0x210000
    s_add_u32 s48, s48, 0x200000
    s_mov_b32 s68, 0
    s_waitcnt lgkmcnt(0)
    s_add_u32 s32, s32, 0x0
    s_addc_u32 s33, s33, 0
    s_load_dword s43, s[32:33], s48
    s_load_dwordx2 s[28:29], s[0:1], 48
    v_lshlrev_b32 v56, 7, v1
    s_cmp_ge_u32 s49, 64
    s_cbranch_scc1 L_free
    s_lshr_b32 s47, s49, 3
    s_mul_i32 s47, s47, 5120
    s_mul_i32 s48, s40, 640
    s_add_u32 s47, s47, s48
    s_add_u32 s47, s47, 32768
    s_mov_b64 exec, 0x1f
    buffer_load_dword v4, v56, s[20:23], s47 offen
    s_mov_b64 exec, -1
    v_lshrrev_b32 v53, 3, v0
    s_mov_b32 s47, 0x200000
    v_lshlrev_b32 v53, 2, v53
    buffer_load_dword v212, v53, s[32:35], s47 offen offset:0
    buffer_load_dword v213, v53, s[32:35], s47 offen offset:256
    buffer_load_dword v214, v53, s[32:35], s47 offen offset:512
    buffer_load_dword v215, v53, s[32:35], s47 offen offset:768
    v_mov_b32 v56, 0
    v_mov_b32 v57, 0
    v_mov_b32 v58, 0
    v_mov_b32 v59, 0
    v_mov_b32 v188, 153984
    v_and_b32 v54, 0xff, v0
    v_mul_u32_u24 v60, 160, v54
    v_add_u32 v60, 113024, v60
    v_mov_b32 v61, 0
    v_lshl_add_u32 v54, v54, 3, v188
    v_add_u32 v55, 113024, v2
    ds_write_b128 v55, v[56:59] offset:0
    ds_write_b128 v55, v[56:59] offset:8192
    ds_write_b128 v55, v[56:59] offset:16384
    ds_write_b128 v55, v[56:59] offset:24576
    ds_write_b128 v55, v[56:59] offset:32768
    ds_write_b64 v54, v[60:61]
    v_lshlrev_b32 v62, 8, v0
    v_add_u32 v138, 12, v62
    v_add_u32 v139, 76, v62
    v_add_u32 v140, 140, v62
    v_add_u32 v141, 204, v62
    v_lshlrev_b32 v62, 6, v0
    v_add_u32 v142, 131084, v62
    v_cmp_gt_u32 vcc, 452, v0
    s_mov_b64 s[56:57], vcc
    v_mov_b32 v63, 160
    v_mov_b32 v64, 113148
    v_mov_b32 v118, 4
    v_mov_b32 v120, 4
    v_mov_b32 v122, 4
    v_mov_b32 v124, 4
    v_mov_b32 v126, 4
    v_lshrrev_b32 v184, 3, v0
    v_and_b32 v62, 7, v0
    v_lshlrev_b32 v185, 13, v184
    v_lshl_add_u32 v185, v62, 4, v185
    v_mul_u32_u24 v187, 160, v184
    v_add_u32 v187, 113024, v187
    v_lshl_add_u32 v186, v62, 2, v187
    v_add_u32 v187, 124, v187
    v_lshl_add_u32 v184, v184, 3, v188
    s_lshl_b32 s75, s49, 7
    s_waitcnt lgkmcnt(0)
    s_barrier
    s_cmp_ge_u32 s40, 5
    s_cbranch_scc1 L_g_7
    s_add_u32 m0, s46, 69632
    s_mul_i32 s47, s2, 10240
    s_add_u32 s47, s47, s46
    buffer_load_dwordx4 v33, s[4:7], s47 offen lds
    buffer_load_dwordx4 v34, s[4:7], s47 offen offset:1024 lds
    s_branch L_g_8
L_g_7:
    s_and_b32 s47, s46, 2048
    s_add_u32 s47, s47, 65536
    s_mov_b32 m0, s47
    s_nop 0
    buffer_load_dwordx4 v3, s[20:23], s47 offen offset:0 lds
    buffer_load_dwordx4 v3, s[20:23], s47 offen offset:1024 lds
L_g_8:
    s_add_u32 s47, s45, 32768
    s_mov_b32 m0, s47
    s_nop 0
    buffer_load_dwordx4 v3, s[20:23], s47 offen offset:0 lds
    buffer_load_dwordx4 v3, s[20:23], s47 offen offset:1024 lds
    buffer_load_dwordx4 v3, s[20:23], s47 offen offset:2048 lds
    buffer_load_dwordx4 v3, s[20:23], s47 offen offset:3072 lds
    s_mov_b32 m0, s45
    s_mov_b32 s47, 52429
    s_mov_b32 s48, 0xffffffd8
    s_waitcnt vmcnt(11)
    v_mul_u32_u24 v112, s47, v144
    v_lshlrev_b32 v152, 18, v152
    v_lshrrev_b32 v112, 21, v112
    v_add3_u32 v152, v144, v138, v152
    v_lshl_add_u32 v144, v112, 3, v188
    v_mad_i32_i24 v119, v112, s48, v152
    ds_add_rtn_u64 v[128:129], v144, v[118:119]
    v_mul_u32_u24 v113, s47, v145
    v_lshlrev_b32 v153, 18, v153
    v_lshrrev_b32 v113, 21, v113
    v_add3_u32 v153, v145, v139, v153
    v_lshl_add_u32 v145, v113, 3, v188
    v_mad_i32_i24 v121, v113, s48, v153
    ds_add_rtn_u64 v[130:131], v145, v[120:121]
    v_mul_u32_u24 v114, s47, v146
    v_lshlrev_b32 v154, 18, v154
    v_lshrrev_b32 v114, 21, v114
    v_add3_u32 v154, v146, v140, v154
    v_lshl_add_u32 v146, v114, 3, v188
    v_mad_i32_i24 v123, v114, s48, v154
    ds_add_rtn_u64 v[132:133], v146, v[122:123]
    v_mul_u32_u24 v115, s47, v147
    v_lshlrev_b32 v155, 18, v155
    v_lshrrev_b32 v115, 21, v115
    v_add3_u32 v155, v147, v141, v155
    v_lshl_add_u32 v147, v115, 3, v188
    v_mad_i32_i24 v125, v115, s48, v155
    ds_add_rtn_u64 v[134:135], v147, v[124:125]
    s_mov_b64 exec, s[56:57]
    v_mul_u32_u24 v116, s47, v148
    v_lshlrev_b32 v156, 18, v156
    v_lshrrev_b32 v116, 21, v116
    v_add3_u32 v156, v148, v142, v156
    v_lshl_add_u32 v148, v116, 3, v188
    v_mad_i32_i24 v127, v116, s48, v156
    ds_add_rtn_u64 v[136:137], v148, v[126:127]
    s_mov_b64 exec, -1
    v_mad_u32_u24 v112, v112, v63, v64
    v_mad_u32_u24 v113, v113, v63, v64
    v_mad_u32_u24 v114, v114, v63, v64
    v_mad_u32_u24 v115, v115, v63, v64
    v_mad_u32_u24 v116, v116, v63, v64
    s_waitcnt vmcnt(6)
    s_mov_b32 s48, 0x9e3779b1
    v_mul_lo_u32 v212, v212, s48
    v_xor_b32 v212, 0x5bd1e995, v212
    v_mul_lo_u32 v213, v213, s48
    v_xor_b32 v213, 0x5bd1e995, v213
    v_mul_lo_u32 v214, v214, s48
    v_xor_b32 v214, 0x5bd1e995, v214
    v_mul_lo_u32 v215, v215, s48
    v_xor_b32 v215, 0x5bd1e995, v215
    s_waitcnt lgkmcnt(4)
    v_min_u32 v112, v112, v128
    ds_write_b32 v112, v119
    s_waitcnt lgkmcnt(4)
    v_min_u32 v113, v113, v130
    ds_write_b32 v113, v121
    s_waitcnt lgkmcnt(4)
    v_min_u32 v114, v114, v132
    ds_write_b32 v114, v123
    s_waitcnt lgkmcnt(4)
    v_min_u32 v115, v115, v134
    ds_write_b32 v115, v125
    s_mov_b64 exec, s[56:57]
    s_waitcnt lgkmcnt(4)
    v_min_u32 v116, v116, v136
    ds_write_b32 v116, v127
    s_mov_b64 exec, -1
    s_mov_b32 s34, 0x1f4000
    s_waitcnt lgkmcnt(0)
    s_barrier
    ds_read_b64 v[128:129], v184 offset:0
    ds_read2_b32 v[112:113], v186 offset0:0 offset1:8
    ds_read2_b32 v[114:115], v186 offset0:16 offset1:24
    v_add_u32 v186, 10240, v186
    ds_read_b64 v[130:131], v184 offset:512
    ds_read2_b32 v[116:117], v186 offset0:0 offset1:8
    ds_read2_b32 v[118:119], v186 offset0:16 offset1:24
    v_add_u32 v186, 10240, v186
    ds_read_b64 v[132:133], v184 offset:1024
    ds_read2_b32 v[120:121], v186 offset0:0 offset1:8
    ds_read2_b32 v[122:123], v186 offset0:16 offset1:24
    v_add_u32 v186, 10240, v186
    ds_read_b64 v[134:135], v184 offset:1536
    ds_read2_b32 v[124:125], v186 offset0:0 offset1:8
    ds_read2_b32 v[126:127], v186 offset0:16 offset1:24
    s_waitcnt lgkmcnt(9)
    v_cmp_lt_u32 vcc, v187, v128
    v_add_u32 v129, v129, v212
    s_cbranch_vccnz L_ov_9
L_ovr_10:
    v_add_u32 v187, 10240, v187
    v_cndmask_b32 v115, v115, v129, s[62:63]
    buffer_store_dwordx4 v[112:115], v185, s[32:35], s75 offen sc1
    s_add_u32 s75, s75, 524288
    s_waitcnt lgkmcnt(6)
    v_cmp_lt_u32 vcc, v187, v130
    v_add_u32 v131, v131, v213
    s_cbranch_vccnz L_ov_11
L_ovr_12:
    v_add_u32 v187, 10240, v187
    v_cndmask_b32 v119, v119, v131, s[62:63]
    buffer_store_dwordx4 v[116:119], v185, s[32:35], s75 offen sc1
    s_add_u32 s75, s75, 524288
    s_waitcnt lgkmcnt(3)
    v_cmp_lt_u32 vcc, v187, v132
    v_add_u32 v133, v133, v214
    s_cbranch_vccnz L_ov_13
L_ovr_14:
    v_add_u32 v187, 10240, v187
    v_cndmask_b32 v123, v123, v133, s[62:63]
    buffer_store_dwordx4 v[120:123], v185, s[32:35], s75 offen sc1
    s_add_u32 s75, s75, 524288
    s_waitcnt lgkmcnt(0)
    v_cmp_lt_u32 vcc, v187, v134
    v_add_u32 v135, v135, v215
    s_cbranch_vccnz L_ov_15
L_ovr_16:
    v_add_u32 v187, 10240, v187
    v_cndmask_b32 v127, v127, v135, s[62:63]
    buffer_store_dwordx4 v[124:127], v185, s[32:35], s75 offen sc1
    s_add_u32 s75, s75, 524288
    s_mov_b32 s34, 0x500000
    s_barrier
    s_mov_b32 m0, s45
    s_nop 0
    buffer_load_dwordx4 v3, s[24:27], s45 offen offset:0 lds
    buffer_load_dwordx4 v3, s[24:27], s45 offen offset:1024 lds
    buffer_load_dwordx4 v3, s[24:27], s45 offen offset:2048 lds
    buffer_load_dwordx4 v3, s[24:27], s45 offen offset:3072 lds
    s_branch L_setup
L_ov_9:
    s_mov_b64 exec, vcc
    v_mov_b32 v112, 0
    v_mov_b32 v113, 0
    v_mov_b32 v114, 0
    v_mov_b32 v115, 0
    v_add_u32 v129, -1, v212
    s_mov_b64 exec, -1
    s_branch L_ovr_10
L_ov_11:
    s_mov_b64 exec, vcc
    v_mov_b32 v116, 0
    v_mov_b32 v117, 0
    v_mov_b32 v118, 0
    v_mov_b32 v119, 0
    v_add_u32 v131, -1, v213
    s_mov_b64 exec, -1
    s_branch L_ovr_12
L_ov_13:
    s_mov_b64 exec, vcc
    v_mov_b32 v120, 0
    v_mov_b32 v121, 0
    v_mov_b32 v122, 0
    v_mov_b32 v123, 0
    v_add_u32 v133, -1, v214
    s_mov_b64 exec, -1
    s_branch L_ovr_14
L_ov_15:
    s_mov_b64 exec, vcc
    v_mov_b32 v124, 0
    v_mov_b32 v125, 0
    v_mov_b32 v126, 0
    v_mov_b32 v127, 0
    v_add_u32 v135, -1, v215
    s_mov_b64 exec, -1
    s_branch L_ovr_16
L_free:
    s_sub_u32 s47, s2, 221
    s_lshr_b32 s47, s47, 3
    s_mul_i32 s47, s47, 22528
    s_mul_i32 s48, s40, 2816
    s_add_u32 s47, s47, s48
    s_mov_b64 exec, 0x3fffff
    buffer_load_dword v4, v56, s[24:27], s47 offen
    s_mov_b64 exec, -1
    s_cmp_ge_u32 s40, 5
    s_cbranch_scc1 L_g_17
    s_add_u32 m0, s46, 69632
    s_mul_i32 s47, s2, 10240
    s_add_u32 s47, s47, s46
    buffer_load_dwordx4 v33, s[4:7], s47 offen lds
    buffer_load_dwordx4 v34, s[4:7], s47 offen offset:1024 lds
    s_branch L_g_18
L_g_17:
    s_and_b32 s47, s46, 2048
    s_add_u32 s47, s47, 65536
    s_mov_b32 m0, s47
    s_nop 0
    buffer_load_dwordx4 v3, s[20:23], s47 offen offset:0 lds
    buffer_load_dwordx4 v3, s[20:23], s47 offen offset:1024 lds
L_g_18:
    s_add_u32 s47, s45, 32768
    s_mov_b32 m0, s47
    s_nop 0
    buffer_load_dwordx4 v3, s[20:23], s47 offen offset:0 lds
    buffer_load_dwordx4 v3, s[20:23], s47 offen offset:1024 lds
    buffer_load_dwordx4 v3, s[20:23], s47 offen offset:2048 lds
    buffer_load_dwordx4 v3, s[20:23], s47 offen offset:3072 lds
    s_mov_b32 m0, s45
    s_nop 0
    buffer_load_dwordx4 v3, s[24:27], s45 offen offset:0 lds
    buffer_load_dwordx4 v3, s[24:27], s45 offen offset:1024 lds
    buffer_load_dwordx4 v3, s[24:27], s45 offen offset:2048 lds
    buffer_load_dwordx4 v3, s[24:27], s45 offen offset:3072 lds
    s_branch L_setup
L_notpm2:
    s_cmp_lt_u32 s49, 64
    s_waitcnt vmcnt(8) lgkmcnt(0)
    s_cbranch_scc1 L_q0
    s_waitcnt vmcnt(4)
    s_branch L_q0
L_slow:
    s_mov_b32 s69, 1
    s_mov_b32 s70, 0
    s_mov_b32 s73, 0
    s_mov_b64 s[60:61], 0
    s_branch L_slow_round
L_slow_next:
    s_cmp_eq_u32 s69, 2
    s_cbranch_scc1 L_epi
L_slow_round:
    s_waitcnt vmcnt(0) lgkmcnt(0)
    s_barrier
    v_mov_b32 v56, 0
    v_mov_b32 v60, 0x100000
    v_mov_b32 v57, 0
    v_mov_b32 v61, 0x100000
    v_mov_b32 v58, 0
    v_mov_b32 v62, 0x100000
    v_mov_b32 v59, 0
    v_mov_b32 v63, 0x100000
    v_add_u32 v64, 112960, v2
    ds_write_b128 v64, v[56:59] offset:0
    ds_write_b128 v64, v[56:59] offset:8192
    ds_write_b128 v64, v[56:59] offset:16384
    ds_write_b128 v64, v[56:59] offset:24576
    ds_write_b128 v64, v[56:59] offset:32768
    ds_write_b128 v64, v[60:63] offset:41280
    s_cmp_lg_u32 s40, 0
    s_cbranch_scc1 L_il_19
    ds_write_b128 v64, v[60:63] offset:49472
    s_mov_b64 exec, 0xfffff
    ds_write_b128 v64, v[56:59] offset:40960
    s_mov_b64 exec, 0xf
    v_cmp_eq_u32 vcc, 2, v0
    v_mov_b32 v61, 1152
    v_add_u32 v60, 112896, v2
    v_cndmask_b32 v56, 0, v61, vcc
    ds_write_b128 v60, v[56:59]
    s_mov_b64 exec, -1
L_il_19:
L_slow_fill:
    s_waitcnt lgkmcnt(0)
    s_barrier
    s_cmp_lg_u32 s73, 0
    s_cbranch_scc1 L_slow_place
    v_add_u32 v25, s70, v0
    v_lshlrev_b32 v52, 2, v25
    buffer_load_dword v26, v52, s[16:19], 0 offen
    buffer_load_dword v24, v52, s[12:15], 0 offen
    s_mul_i32 s45, s2, 40
    s_mov_b32 s46, 160000
    s_add_u32 s70, s70, 512
    s_waitcnt vmcnt(0)
    v_subrev_u32 v26, s45, v26
    v_cmp_gt_u32 vcc, 40, v26
    v_cmp_gt_u32 s[60:61], s46, v25
    v_add_u32 v26, 12, v26
    s_and_b64 s[60:61], s[60:61], vcc
L_slow_place:
    s_mov_b64 exec, s[60:61]
    s_mov_b32 s48, 912
    v_and_or_b32 v52, v26, 32, v30
    ds_add_rtn_u32 v52, v52, v27
    v_mad_u32_u24 v53, v26, s48, v31
    v_and_b32 v54, 32, v26
    v_mul_u32_u24 v54, 36, v54
    v_add_u32 v54, 896, v54
    s_waitcnt lgkmcnt(0)
    v_cmp_lt_u32 vcc, v52, v54
    s_and_b64 exec, exec, vcc
    v_add_u32 v53, v53, v52
    v_lshl_add_u32 v52, v52, 2, v32
    ds_write_b16 v53, v28
    ds_write_b64 v52, v[24:25]
    s_andn2_b64 s[60:61], s[60:61], exec
    s_mov_b64 exec, -1
    s_waitcnt lgkmcnt(0)
    s_barrier
    ds_read2_b32 v[52:53], v30 offset0:0 offset1:8
    s_waitcnt lgkmcnt(0)
    v_readfirstlane_b32 s45, v52
    v_readfirstlane_b32 s46, v53
    s_sub_u32 s46, s46, 1152
    s_max_u32 s47, s45, s46
    s_cmp_eq_u32 s42, 0
    s_cselect_b32 s66, s45, s46
    s_min_u32 s66, s66, 896
    s_cmp_gt_u32 s47, 896
    s_cselect_b32 s73, 1, 0
    s_cbranch_scc1 L_slow_go
    s_cmp_lt_u32 s70, 160000
    s_cbranch_scc1 L_slow_fill
    s_mov_b32 s69, 2
L_slow_go:
    s_lshl_b32 s47, s41, 8
    v_add_u32 v56, s47, v16
    s_mul_i32 s47, s42, 3072
    s_add_u32 s47, s47, 81920
    s_sub_u32 s48, s47, s74
    v_add_u32 v6, s48, v12
    s_lshl_b32 s48, s41, 10
    s_add_u32 m0, s47, s48
    v_mov_b32 v113, v19
    v_mov_b32 v115, v19
    v_mov_b32 v117, v19
    v_mov_b32 v119, v19
    v_mov_b32 v121, v19
    v_mov_b32 v123, v19
    v_mov_b32 v124, 0x100000
    ds_read_b32 v22, v56 offset:4
    ds_read_b32 v112, v15 offset:0
    ds_read_b32 v114, v15 offset:128
    ds_read_b32 v116, v15 offset:256
    ds_read_b32 v118, v15 offset:384
    ds_read_b32 v120, v15 offset:512
    ds_read_b32 v122, v15 offset:640
    s_waitcnt lgkmcnt(0)
    s_cmp_eq_u32 s41, 3
    s_cbranch_scc1 L_e_20
    buffer_load_dwordx4 v[22:23], s[8:11], 0 idxen offen lds
L_e_20:
    s_waitcnt vmcnt(0)
    s_barrier
    s_add_u32 m0, s72, 0
    s_nop 0
    buffer_load_dwordx4 v[112:113], s[36:39], 0 idxen offen lds
    s_add_u32 m0, s72, 1024
    s_nop 0
    buffer_load_dwordx4 v[114:115], s[36:39], 0 idxen offen lds
    v_mov_b32 v7, v13
    v_mov_b32 v8, v14
    v_mov_b32 v9, v15
    v_mov_b32 v10, v16
    v_mov_b32 v194, 0
    v_mov_b32 v195, 0
    v_mov_b32 v160, 0
    v_mov_b32 v204, 0
    v_mov_b32 v161, 0
    v_mov_b32 v205, 0
    v_mov_b32 v162, 0
    v_mov_b32 v206, 0
    v_mov_b32 v163, 0
    v_mov_b32 v207, 0
    v_mov_b32 v164, 0
    v_mov_b32 v208, 0
    v_mov_b32 v165, 0
    v_mov_b32 v209, 0
    v_mov_b32 v166, 0
    v_mov_b32 v210, 0
    v_mov_b32 v167, 0
    v_mov_b32 v211, 0
    v_mov_b32 v168, 0
    v_mov_b32 v169, 0
    v_mov_b32 v170, 0
    v_mov_b32 v171, 0
    v_mov_b32 v172, 0
    v_mov_b32 v173, 0
    v_mov_b32 v174, 0
    v_mov_b32 v175, 0
    v_mov_b32 v176, 0
    v_mov_b32 v177, 0
    v_mov_b32 v178, 0
    v_mov_b32 v179, 0
    v_mov_b32 v180, 0
    v_mov_b32 v181, 0
    v_mov_b32 v182, 0
    v_mov_b32 v183, 0
    s_add_u32 m0, s72, 2048
    s_nop 0
    buffer_load_dwordx4 v[116:117], s[36:39], 0 idxen offen lds
    s_add_u32 m0, s72, 3072
    s_nop 0
    buffer_load_dwordx4 v[118:119], s[36:39], 0 idxen offen lds
    s_add_u32 m0, s72, 4096
    s_nop 0
    buffer_load_dwordx4 v[120:121], s[36:39], 0 idxen offen lds
    s_add_u32 m0, s72, 5120
    s_nop 0
    buffer_load_dwordx4 v[122:123], s[36:39], 0 idxen offen lds
    buffer_load_dword v4, v124, s[8:11], 0 idxen
    s_branch L_process
.section .rodata,"a"
.p2align 6
.amdhsa_kernel standalone__mpnn_edge_mlp__graph_kernel
.amdhsa_next_free_vgpr 248
.amdhsa_next_free_sgpr 79
.amdhsa_accum_offset 248
.amdhsa_group_segment_fixed_size 0
.amdhsa_kernarg_size 72
.amdhsa_user_sgpr_count 2
.amdhsa_user_sgpr_kernarg_segment_ptr 1
.amdhsa_system_sgpr_workgroup_id_x 1
.amdhsa_float_denorm_mode_32 3
.amdhsa_float_denorm_mode_16_64 3
.end_amdhsa_kernel
```
